```python
import torch

def _softmax(x, axis=-1):
    return torch.softmax(x, dim=axis)

def _gelu(x):
    return torch.nn.functional.gelu(x, approximate='tanh')

def _silu(x):
    return torch.nn.functional.silu(x)

def _sigmoid(x):
    return torch.sigmoid(x)

def _layernorm(x, axis=-1, eps=1e-05):
    m = x.mean(dim=axis, keepdim=True)
    v = x.var(dim=axis, keepdim=True, unbiased=False)
    return (x - m) / torch.sqrt(v + eps)

def _scatter_add(tgt, idx, src, axis=0):
    return tgt.clone().index_add_(axis, idx, src)

def _segment_sum(src, seg, n):
    out = torch.zeros((n,) + src.shape[1:], dtype=src.dtype)
    return out.index_add_(0, seg, src)

def _pad(x, pw):
    flat = tuple((v for pair in reversed(pw) for v in pair))
    return torch.nn.functional.pad(x, flat)
kernel_name = 'adaLN_cond__mha_block_cached__glu_gated_glu__decode'

def setup_inputs():

    _w = lambda a: (lambda t: t.to(torch.bfloat16) if t.is_floating_point() else t)(torch.as_tensor(a))

    def _A_setup():
        B, Sq, D = (4, 1, 512)
        H, Sk, Dh = (32, 8192, 128)
        return {'x': _w((lambda *s: torch.randn(*s, dtype=torch.bfloat16) * 0.05)(B, Sq, D)), 'k_cache': _w((lambda *s: torch.randn(*s, dtype=torch.bfloat16) * 3.2)(B, H, Sk, Dh)), 'v_cache': _w((lambda *s: torch.randn(*s, dtype=torch.bfloat16) * 0.4)(B, H, Sk, Dh)), 'wq': _w((lambda *s: torch.randn(*s, dtype=torch.bfloat16) * 3.2)(D, H * Dh) * D ** (-0.5)), 'wo': _w((lambda *s: torch.randn(*s, dtype=torch.bfloat16) * 0.4)(H * Dh, D) * (H * Dh) ** (-0.5))}
    _A_in = _A_setup()

    def _B_setup():
        B, S, D, F = (4, 1, 512, 1792)
        return {'x': _w((lambda *s: torch.randn(*s, dtype=torch.bfloat16) * 0.05)(B, S, D)), 'w_gate': _w((lambda *s: torch.randn(*s, dtype=torch.bfloat16) * 0.05)(D, F)), 'w_up': _w((lambda *s: torch.randn(*s, dtype=torch.bfloat16) * 0.05)(D, F)), 'w_down': _w((lambda *s: torch.randn(*s, dtype=torch.bfloat16) * 0.05)(F, D))}
    _B_in = _B_setup()
    return {'A_x': _A_in['x'], 'A_k_cache': _A_in['k_cache'], 'A_v_cache': _A_in['v_cache'], 'A_wq': _A_in['wq'], 'A_wo': _A_in['wo'], 'B_x': _B_in['x'], 'B_w_gate': _B_in['w_gate'], 'B_w_up': _B_in['w_up'], 'B_w_down': _B_in['w_down'], 'c': _w((lambda *s: torch.randn(*s, dtype=torch.bfloat16) * 0.1)(4, 512) * 8.0), 'w_mod': _w((lambda *s: torch.randn(*s, dtype=torch.bfloat16) * 0.1)(512, 6 * 512) * 512 ** (-0.5) * 8.0)}

def reference(A_x, A_k_cache, A_v_cache, A_wq, A_wo, B_x, B_w_gate, B_w_up, B_w_down, c, w_mod):

    def _A_ref(x, k_cache, v_cache, wq, wo):
        B, Sq, D = x.shape
        H, Dh = (32, 128)
        q = (lambda x, *d: x.permute(*d))((x @ wq).reshape(B, Sq, H, Dh), 0, 2, 1, 3)
        scores = torch.einsum('bhqd,bhkd->bhqk', q, k_cache) * Dh ** (-0.5)
        p = _softmax(scores, axis=-1)
        o = torch.einsum('bhqk,bhkd->bhqd', p, v_cache)
        return (lambda x, *d: x.permute(*d))(o, 0, 2, 1, 3).reshape(B, Sq, H * Dh) @ wo

    def _B_ref(x, w_gate, w_up, w_down):
        g = torch.einsum('bsd,df->bsf', x, w_gate)
        u = torch.einsum('bsd,df->bsf', x, w_up)
        h = _sigmoid(g) * u
        return torch.einsum('bsf,fd->bsd', h, w_down)
    x = A_x
    mod = (_silu(c) @ w_mod).reshape(c.shape[0], 6, 1, -1)
    sa, ca, ga, sb, cb, gb = (mod[:, 0].clone(), mod[:, 1].clone(), mod[:, 2].clone(), mod[:, 3].clone(), mod[:, 4].clone(), mod[:, 5].clone())
    h = _layernorm(x, axis=-1) * (1 + ca) + sa
    x = x + ga * _A_ref(h, A_k_cache, A_v_cache, A_wq, A_wo)
    h = _layernorm(x, axis=-1) * (1 + cb) + sb
    x = x + gb * _B_ref(h, B_w_gate, B_w_up, B_w_down)
    return x
```

```asm
; @launch grid=(256,1,1) block=(512,1,1) lds=41216
.amdgcn_target "amdgcn-amd-amdhsa--gfx950"
.text
.globl adaLN_cond__mha_block_cached__glu_gated_glu__decode_kernel
.p2align 8
.type adaLN_cond__mha_block_cached__glu_gated_glu__decode_kernel,@function
adaLN_cond__mha_block_cached__glu_gated_glu__decode_kernel:
    s_cmp_ge_u32 s2, 256
    s_cbranch_scc1 ABORT
    s_load_dwordx16 s[16:31], s[0:1], 0
    s_load_dwordx8 s[32:39], s[0:1], 64
    s_load_dwordx4 s[40:43], s[0:1], 96
    v_lshrrev_b32 v12, 6, v0
    s_and_b32 s47, s2, 7
    s_lshr_b32 s50, s2, 3
    v_readfirstlane_b32 s46, v12
    s_and_b32 s44, s50, 3
    s_lshr_b32 s50, s50, 2
    s_lshl_b32 s47, s47, 3
    s_add_u32 s45, s47, s50
    s_lshl_b32 s87, s44, 6
    s_add_u32 s87, s87, s45
    s_and_b32 s86, s46, 3
    s_lshl_b32 s47, s44, 8
    s_waitcnt lgkmcnt(0)
    s_load_dwordx2 s[48:49], s[42:43], s47
    s_mov_b32 s60, s42
    s_mov_b32 s61, s43
    s_mov_b32 s62, 4194304
    s_mov_b32 s63, 0x00020000
    v_mov_b32 v59, 0
    v_mov_b32 v63, 0
    s_cmp_ge_u32 s46, 4
    s_cbranch_scc1 AUX
    s_lshr_b32 s50, s87, 1
    s_lshl_b32 s47, s50, 21
    s_lshr_b32 s50, s50, 11
    s_and_b32 s93, s45, 1
    s_lshl_b32 s93, s93, 14
    s_add_u32 s47, s47, s93
    s_add_u32 s52, s18, s47
    s_addc_u32 s53, s19, s50
    s_mov_b32 s54, 2080768
    s_mov_b32 s55, 0x00020000
    s_lshr_b32 s50, s87, 1
    s_lshl_b32 s47, s50, 21
    s_lshr_b32 s50, s50, 11
    s_and_b32 s93, s45, 1
    s_lshl_b32 s93, s93, 14
    s_add_u32 s47, s47, s93
    s_add_u32 s56, s20, s47
    s_addc_u32 s57, s21, s50
    s_mov_b32 s58, 2080768
    s_mov_b32 s59, 0x00020000
    v_and_b32 v1, 63, v0
    s_lshl_b32 s47, s86, 10
    v_lshlrev_b32 v17, 4, v1
    v_add_u32 v17, s47, v17
    s_lshr_b32 s47, s2, 3
    s_and_b32 s50, s2, 7
    s_lshr_b32 s47, s47, 3
    s_lshl2_add_u32 s47, s47, s44
    s_and_b32 s50, s50, 3
    s_lshl4_add_u32 s76, s50, s47
    s_lshl_b32 s76, s76, 15
    s_add_u32 s90, s76, 4096
    s_add_u32 s91, s76, 8192
    s_add_u32 s92, s76, 12288
    buffer_load_dwordx4 v[64:67], v17, s[52:55], s76 offen offset:0 nt
    buffer_load_dwordx4 v[68:71], v17, s[52:55], s90 offen offset:0 nt
    buffer_load_dwordx4 v[72:75], v17, s[52:55], s91 offen offset:0 nt
    buffer_load_dwordx4 v[76:79], v17, s[52:55], s92 offen offset:0 nt
    buffer_load_dwordx4 v[80:83], v17, s[56:59], s76 offen offset:0 nt
    buffer_load_dwordx4 v[84:87], v17, s[56:59], s90 offen offset:0 nt
    buffer_load_dwordx4 v[88:91], v17, s[56:59], s91 offen offset:0 nt
    buffer_load_dwordx4 v[92:95], v17, s[56:59], s92 offen offset:0 nt
    s_add_u32 s76, s76, 32768
    s_and_b32 s76, s76, 2097151
    v_and_b32 v1, 63, v0
    v_and_b32 v2, 15, v0
    v_bfe_u32 v3, v0, 4, 2
    v_and_b32 v12, 1, v2
    v_lshlrev_b32 v12, 4, v12
    v_mov_b32 v13, 0xffff
    v_lshlrev_b32 v13, v12, v13
    v_mov_b32 v14, 0x0100
    v_mov_b32 v15, 0x0302
    v_cmp_gt_u32 vcc, 8, v2
    v_cndmask_b32 v14, v14, v15, vcc
    v_lshlrev_b32 v14, v12, v14
    v_mov_b32 v15, 0x0c0c0c0c
    v_bfi_b32 v14, v13, v14, v15
    v_bfe_u32 v12, v2, 1, 2
    v_cmp_eq_u32 vcc, 0, v12
    v_cndmask_b32 v4, v15, v14, vcc
    v_cndmask_b32 v8, 0, v13, vcc
    v_cmp_eq_u32 vcc, 1, v12
    v_cndmask_b32 v5, v15, v14, vcc
    v_cndmask_b32 v9, 0, v13, vcc
    v_cmp_eq_u32 vcc, 2, v12
    v_cndmask_b32 v6, v15, v14, vcc
    v_cndmask_b32 v10, 0, v13, vcc
    v_cmp_eq_u32 vcc, 3, v12
    v_cndmask_b32 v7, v15, v14, vcc
    v_cndmask_b32 v11, 0, v13, vcc
    s_waitcnt lgkmcnt(0)
    s_mul_i32 s48, s48, 1664525
    s_add_u32 s48, s48, 1013904223
    s_mul_i32 s49, s49, 22695477
    s_add_u32 s49, s49, 1
    v_bfe_u32 v12, v2, 1, 2
    v_lshl_add_u32 v12, v3, 2, v12
    s_lshl_b32 s47, s86, 4
    s_lshl_b32 s50, s44, 6
    s_add_u32 s47, s47, s50
    v_add_u32 v12, s47, v12
    v_lshlrev_b32 v12, 12, v12
    v_and_b32 v13, 1, v2
    v_lshlrev_b32 v13, 5, v13
    v_lshrrev_b32 v14, 3, v2
    v_lshl_add_u32 v13, v14, 4, v13
    s_lshl_b32 s47, s45, 6
    v_add3_u32 v16, v12, v13, s47
    v_mov_b32 v50, s48
    v_mov_b32 v51, s49
    v_mov_b32 v19, 0x3fb8aa3b
    v_mov_b32 v28, 0xff7fffff
    v_mov_b32 v29, 0
    v_mov_b32 v18, 0
    v_mov_b32 v24, 0
    v_mov_b32 v25, 0
    v_mov_b32 v26, 0
    v_mov_b32 v27, 0
    s_add_u32 s90, s76, 4096
    s_add_u32 s91, s76, 8192
    s_add_u32 s92, s76, 12288
    buffer_load_dwordx4 v[96:99], v17, s[52:55], s76 offen offset:0 nt
    buffer_load_dwordx4 v[100:103], v17, s[52:55], s90 offen offset:0 nt
    buffer_load_dwordx4 v[104:107], v17, s[52:55], s91 offen offset:0 nt
    buffer_load_dwordx4 v[108:111], v17, s[52:55], s92 offen offset:0 nt
    s_cmp_ge_u32 s2, 48
    s_cbranch_scc1 NOBM
    s_barrier
NOBM:
    s_waitcnt vmcnt(8)
    buffer_load_dwordx4 v[112:115], v17, s[56:59], s76 offen offset:0 nt
    buffer_load_dwordx4 v[116:119], v17, s[56:59], s90 offen offset:0 nt
    buffer_load_dwordx4 v[120:123], v17, s[56:59], s91 offen offset:0 nt
    buffer_load_dwordx4 v[124:127], v17, s[56:59], s92 offen offset:0 nt
    s_add_u32 s76, s76, 32768
    s_and_b32 s76, s76, 2097151
    s_waitcnt vmcnt(8)
    s_add_u32 s90, s76, 4096
    s_add_u32 s91, s76, 8192
    s_add_u32 s92, s76, 12288
    buffer_load_dwordx4 v[128:131], v17, s[52:55], s76 offen offset:0 nt
    buffer_load_dwordx4 v[132:135], v17, s[52:55], s90 offen offset:0 nt
    buffer_load_dwordx4 v[136:139], v17, s[52:55], s91 offen offset:0 nt
    buffer_load_dwordx4 v[140:143], v17, s[52:55], s92 offen offset:0 nt
    s_waitcnt vmcnt(8)
    buffer_load_dwordx4 v[144:147], v17, s[56:59], s76 offen offset:0 nt
    buffer_load_dwordx4 v[148:151], v17, s[56:59], s90 offen offset:0 nt
    buffer_load_dwordx4 v[152:155], v17, s[56:59], s91 offen offset:0 nt
    buffer_load_dwordx4 v[156:159], v17, s[56:59], s92 offen offset:0 nt
    s_add_u32 s76, s76, 32768
    s_and_b32 s76, s76, 2097151
    s_waitcnt vmcnt(8)
    s_add_u32 s90, s76, 4096
    s_add_u32 s91, s76, 8192
    s_add_u32 s92, s76, 12288
    buffer_load_dwordx4 v[160:163], v17, s[52:55], s76 offen offset:0 nt
    buffer_load_dwordx4 v[164:167], v17, s[52:55], s90 offen offset:0 nt
    buffer_load_dwordx4 v[168:171], v17, s[52:55], s91 offen offset:0 nt
    buffer_load_dwordx4 v[172:175], v17, s[52:55], s92 offen offset:0 nt
    s_waitcnt vmcnt(8)
    buffer_load_dwordx4 v[176:179], v17, s[56:59], s76 offen offset:0 nt
    buffer_load_dwordx4 v[180:183], v17, s[56:59], s90 offen offset:0 nt
    buffer_load_dwordx4 v[184:187], v17, s[56:59], s91 offen offset:0 nt
    buffer_load_dwordx4 v[188:191], v17, s[56:59], s92 offen offset:0 nt
    s_add_u32 s76, s76, 32768
    s_and_b32 s76, s76, 2097151
    s_waitcnt vmcnt(8)
    s_add_u32 s90, s76, 4096
    s_add_u32 s91, s76, 8192
    s_add_u32 s92, s76, 12288
    buffer_load_dwordx4 v[192:195], v17, s[52:55], s76 offen offset:0 nt
    buffer_load_dwordx4 v[196:199], v17, s[52:55], s90 offen offset:0 nt
    buffer_load_dwordx4 v[200:203], v17, s[52:55], s91 offen offset:0 nt
    buffer_load_dwordx4 v[204:207], v17, s[52:55], s92 offen offset:0 nt
    s_waitcnt vmcnt(8)
    buffer_load_dwordx4 v[208:211], v17, s[56:59], s76 offen offset:0 nt
    buffer_load_dwordx4 v[212:215], v17, s[56:59], s90 offen offset:0 nt
    buffer_load_dwordx4 v[216:219], v17, s[56:59], s91 offen offset:0 nt
    buffer_load_dwordx4 v[220:223], v17, s[56:59], s92 offen offset:0 nt
    s_add_u32 s76, s76, 32768
    s_and_b32 s76, s76, 2097151
    s_waitcnt vmcnt(8)
    s_add_u32 s90, s76, 4096
    s_add_u32 s91, s76, 8192
    s_add_u32 s92, s76, 12288
    buffer_load_dwordx4 v[224:227], v17, s[52:55], s76 offen offset:0 nt
    buffer_load_dwordx4 v[228:231], v17, s[52:55], s90 offen offset:0 nt
    buffer_load_dwordx4 v[232:235], v17, s[52:55], s91 offen offset:0 nt
    buffer_load_dwordx4 v[236:239], v17, s[52:55], s92 offen offset:0 nt
    s_waitcnt vmcnt(8)
    buffer_load_dwordx4 v[240:243], v17, s[56:59], s76 offen offset:0 nt
    buffer_load_dwordx4 v[244:247], v17, s[56:59], s90 offen offset:0 nt
    buffer_load_dwordx4 v[248:251], v17, s[56:59], s91 offen offset:0 nt
    buffer_load_dwordx4 v[252:255], v17, s[56:59], s92 offen offset:0 nt
    s_add_u32 s76, s76, 32768
    s_and_b32 s76, s76, 2097151
    s_barrier
WP4_0:
    s_cbranch_execz WP4_1
    v_lshlrev_b32 v12, 6, v2
    ds_read_b128 v[32:35], v12 offset:0
    ds_read_b128 v[36:39], v12 offset:1024
    ds_read_b128 v[40:43], v12 offset:2048
    ds_read_b128 v[44:47], v12 offset:3072
    s_waitcnt lgkmcnt(0)
WP4_1:
    s_cbranch_execz WP4_2
    v_add_f32 v32, v32, v36
    v_add_f32 v40, v40, v44
    v_add_f32 v33, v33, v37
    v_add_f32 v41, v41, v45
    v_add_f32 v34, v34, v38
    v_add_f32 v42, v42, v46
    v_add_f32 v35, v35, v39
    v_add_f32 v43, v43, v47
    v_add_f32 v32, v32, v40
    v_add_f32 v33, v33, v41
    v_add_f32 v34, v34, v42
    v_add_f32 v35, v35, v43
    v_cvt_pk_bf16_f32 v20, v32, v33
    v_cvt_pk_bf16_f32 v21, v34, v35
WP4_2:
    s_cbranch_execz WP4_3
    ds_read_b128 v[32:35], v12 offset:16
    ds_read_b128 v[36:39], v12 offset:1040
    ds_read_b128 v[40:43], v12 offset:2064
    ds_read_b128 v[44:47], v12 offset:3088
    s_waitcnt lgkmcnt(0)
    v_add_f32 v32, v32, v36
    v_add_f32 v40, v40, v44
    v_add_f32 v33, v33, v37
    v_add_f32 v41, v41, v45
    v_add_f32 v34, v34, v38
WP4_3:
    s_cbranch_execz WP4_4
    v_add_f32 v42, v42, v46
    v_add_f32 v35, v35, v39
    v_add_f32 v43, v43, v47
    v_add_f32 v32, v32, v40
    v_add_f32 v33, v33, v41
    v_add_f32 v34, v34, v42
    v_add_f32 v35, v35, v43
    v_cvt_pk_bf16_f32 v22, v32, v33
    v_cvt_pk_bf16_f32 v23, v34, v35
    s_waitcnt vmcnt(12)
    s_mov_b32 s77, 9
MAINLOOP:
    v_dot2_f32_bf16 v32, v64, v20, 0
WP4_4:
    s_cbranch_execz WP4_5
    v_dot2_f32_bf16 v33, v68, v20, 0
    v_dot2_f32_bf16 v34, v72, v20, 0
    v_dot2_f32_bf16 v35, v76, v20, 0
    v_dot2_f32_bf16 v32, v65, v21, v32
    v_dot2_f32_bf16 v33, v69, v21, v33
    v_dot2_f32_bf16 v34, v73, v21, v34
    v_dot2_f32_bf16 v35, v77, v21, v35
    v_dot2_f32_bf16 v32, v66, v22, v32
WP4_5:
    s_cbranch_execz WP4_6
    v_dot2_f32_bf16 v33, v70, v22, v33
    v_dot2_f32_bf16 v34, v74, v22, v34
    v_dot2_f32_bf16 v35, v78, v22, v35
    v_dot2_f32_bf16 v32, v67, v23, v32
    v_dot2_f32_bf16 v33, v71, v23, v33
    v_dot2_f32_bf16 v34, v75, v23, v34
    v_dot2_f32_bf16 v35, v79, v23, v35
WP4_6:
    s_cbranch_execz WP4_7
    s_waitcnt vmcnt(8)
    s_add_u32 s90, s76, 4096
    s_add_u32 s91, s76, 8192
    s_add_u32 s92, s76, 12288
    buffer_load_dwordx4 v[64:67], v17, s[52:55], s76 offen offset:0 nt
    buffer_load_dwordx4 v[68:71], v17, s[52:55], s90 offen offset:0 nt
    buffer_load_dwordx4 v[72:75], v17, s[52:55], s91 offen offset:0 nt
    buffer_load_dwordx4 v[76:79], v17, s[52:55], s92 offen offset:0 nt
WP4_7:
    s_cbranch_execz WP4_8
    s_nop 2
    v_add_f32_dpp v30, v32, v32 row_ror:8 row_mask:0xf bank_mask:0xf
    v_add_f32_dpp v31, v33, v33 row_ror:8 row_mask:0xf bank_mask:0xf
    v_add_f32_dpp v30, v34, v34 row_ror:8 row_mask:0xf bank_mask:0xc
    v_add_f32_dpp v31, v35, v35 row_ror:8 row_mask:0xf bank_mask:0xc
    s_nop 0
    v_add_f32_dpp v36, v30, v30 row_half_mirror row_mask:0xf bank_mask:0x5
    v_add_f32_dpp v36, v31, v31 row_half_mirror row_mask:0xf bank_mask:0xa
    s_nop 1
WP4_8:
    s_cbranch_execz WP4_9
    v_add_f32_dpp v36, v36, v36 quad_perm:[1,0,3,2] row_mask:0xf bank_mask:0xf
    s_nop 1
    v_add_f32_dpp v36, v36, v36 quad_perm:[2,3,0,1] row_mask:0xf bank_mask:0xf
    v_cvt_pk_bf16_f32 v36, 0, v36
    v_mul_f32 v36, 0x3db504f3, v36
    v_cvt_pk_bf16_f32 v36, 0, v36
    v_cmp_lt_f32 vcc, v28, v36
    s_cbranch_vccnz RESC_1
CONT_2:
    v_fma_f32 v30, v36, v19, v29
WP4_9:
    s_cbranch_execz WP4_10
    v_exp_f32 v30, v30
    s_nop 0
    v_add_f32 v18, v18, v30
    v_cvt_pk_bf16_f32 v31, 0, v30
    v_sub_f32 v31, v30, v31
    v_cvt_pk_bf16_f32 v37, v31, v30
    s_nop 1
    v_mov_b32_dpp v38, v37 row_newbcast:0 row_mask:0xf bank_mask:0xf
    v_perm_b32 v40, v38, v38, v4
    v_perm_b32 v41, v38, v38, v5
WP4_10:
    s_cbranch_execz WP4_11
    v_perm_b32 v42, v38, v38, v6
    v_perm_b32 v43, v38, v38, v7
    v_mov_b32_dpp v39, v37 row_newbcast:4 row_mask:0xf bank_mask:0xf
    v_perm_b32 v44, v39, v39, v4
    v_perm_b32 v45, v39, v39, v5
    v_perm_b32 v46, v39, v39, v6
    v_perm_b32 v47, v39, v39, v7
    v_mfma_f32_16x16x32_bf16 v[24:27], v[80:83], v[40:43], v[24:27]
WP4_11:
    s_cbranch_execz WP4_12
    v_mov_b32_dpp v38, v37 row_newbcast:8 row_mask:0xf bank_mask:0xf
    v_perm_b32 v40, v38, v38, v4
    v_perm_b32 v41, v38, v38, v5
    v_perm_b32 v42, v38, v38, v6
    v_perm_b32 v43, v38, v38, v7
    v_mfma_f32_16x16x32_bf16 v[24:27], v[84:87], v[44:47], v[24:27]
    v_mov_b32_dpp v39, v37 row_newbcast:12 row_mask:0xf bank_mask:0xf
WP4_12:
    s_cbranch_execz WP4_13
    v_perm_b32 v44, v39, v39, v4
    v_perm_b32 v45, v39, v39, v5
    v_perm_b32 v46, v39, v39, v6
    v_perm_b32 v47, v39, v39, v7
    v_mfma_f32_16x16x32_bf16 v[24:27], v[88:91], v[40:43], v[24:27]
    s_nop 1
    v_mfma_f32_16x16x32_bf16 v[24:27], v[92:95], v[44:47], v[24:27]
    s_waitcnt vmcnt(8)
    buffer_load_dwordx4 v[80:83], v17, s[56:59], s76 offen offset:0 nt
WP4_13:
    s_cbranch_execz WP4_14
    buffer_load_dwordx4 v[84:87], v17, s[56:59], s90 offen offset:0 nt
    buffer_load_dwordx4 v[88:91], v17, s[56:59], s91 offen offset:0 nt
    buffer_load_dwordx4 v[92:95], v17, s[56:59], s92 offen offset:0 nt
    s_add_u32 s76, s76, 32768
    s_and_b32 s76, s76, 2097151
    v_dot2_f32_bf16 v32, v96, v20, 0
    v_dot2_f32_bf16 v33, v100, v20, 0
WP4_14:
    s_cbranch_execz WP4_15
    v_dot2_f32_bf16 v34, v104, v20, 0
    v_dot2_f32_bf16 v35, v108, v20, 0
    v_dot2_f32_bf16 v32, v97, v21, v32
    v_dot2_f32_bf16 v33, v101, v21, v33
    v_dot2_f32_bf16 v34, v105, v21, v34
    v_dot2_f32_bf16 v35, v109, v21, v35
    v_dot2_f32_bf16 v32, v98, v22, v32
    v_dot2_f32_bf16 v33, v102, v22, v33
WP4_15:
    s_cbranch_execz WP4_16
    v_dot2_f32_bf16 v34, v106, v22, v34
    v_dot2_f32_bf16 v35, v110, v22, v35
    v_dot2_f32_bf16 v32, v99, v23, v32
    v_dot2_f32_bf16 v33, v103, v23, v33
    v_dot2_f32_bf16 v34, v107, v23, v34
    v_dot2_f32_bf16 v35, v111, v23, v35
    s_waitcnt vmcnt(8)
    s_add_u32 s90, s76, 4096
WP4_16:
    s_cbranch_execz WP4_17
    s_add_u32 s91, s76, 8192
    s_add_u32 s92, s76, 12288
    buffer_load_dwordx4 v[96:99], v17, s[52:55], s76 offen offset:0 nt
    buffer_load_dwordx4 v[100:103], v17, s[52:55], s90 offen offset:0 nt
    buffer_load_dwordx4 v[104:107], v17, s[52:55], s91 offen offset:0 nt
    buffer_load_dwordx4 v[108:111], v17, s[52:55], s92 offen offset:0 nt
    s_nop 2
    v_add_f32_dpp v30, v32, v32 row_ror:8 row_mask:0xf bank_mask:0xf
WP4_17:
    s_cbranch_execz WP4_18
    v_add_f32_dpp v31, v33, v33 row_ror:8 row_mask:0xf bank_mask:0xf
    v_add_f32_dpp v30, v34, v34 row_ror:8 row_mask:0xf bank_mask:0xc
    v_add_f32_dpp v31, v35, v35 row_ror:8 row_mask:0xf bank_mask:0xc
    s_nop 0
    v_add_f32_dpp v36, v30, v30 row_half_mirror row_mask:0xf bank_mask:0x5
    v_add_f32_dpp v36, v31, v31 row_half_mirror row_mask:0xf bank_mask:0xa
    s_nop 1
    v_add_f32_dpp v36, v36, v36 quad_perm:[1,0,3,2] row_mask:0xf bank_mask:0xf
WP4_18:
    s_cbranch_execz WP4_19
    s_nop 1
    v_add_f32_dpp v36, v36, v36 quad_perm:[2,3,0,1] row_mask:0xf bank_mask:0xf
    v_cvt_pk_bf16_f32 v36, 0, v36
    v_mul_f32 v36, 0x3db504f3, v36
    v_cvt_pk_bf16_f32 v36, 0, v36
    v_cmp_lt_f32 vcc, v28, v36
    s_cbranch_vccnz RESC_3
CONT_4:
    v_fma_f32 v30, v36, v19, v29
    v_exp_f32 v30, v30
    s_nop 0
WP4_19:
    s_cbranch_execz WP4_20
    v_add_f32 v18, v18, v30
    v_cvt_pk_bf16_f32 v31, 0, v30
    v_sub_f32 v31, v30, v31
    v_cvt_pk_bf16_f32 v37, v31, v30
    s_nop 1
    v_mov_b32_dpp v38, v37 row_newbcast:0 row_mask:0xf bank_mask:0xf
    v_perm_b32 v40, v38, v38, v4
    v_perm_b32 v41, v38, v38, v5
    v_perm_b32 v42, v38, v38, v6
WP4_20:
    s_cbranch_execz WP4_21
    v_perm_b32 v43, v38, v38, v7
    v_mov_b32_dpp v39, v37 row_newbcast:4 row_mask:0xf bank_mask:0xf
    v_perm_b32 v44, v39, v39, v4
    v_perm_b32 v45, v39, v39, v5
    v_perm_b32 v46, v39, v39, v6
    v_perm_b32 v47, v39, v39, v7
    v_mfma_f32_16x16x32_bf16 v[24:27], v[112:115], v[40:43], v[24:27]
    v_mov_b32_dpp v38, v37 row_newbcast:8 row_mask:0xf bank_mask:0xf
WP4_21:
    s_cbranch_execz WP4_22
    v_perm_b32 v40, v38, v38, v4
    v_perm_b32 v41, v38, v38, v5
    v_perm_b32 v42, v38, v38, v6
    v_perm_b32 v43, v38, v38, v7
    v_mfma_f32_16x16x32_bf16 v[24:27], v[116:119], v[44:47], v[24:27]
    v_mov_b32_dpp v39, v37 row_newbcast:12 row_mask:0xf bank_mask:0xf
    v_perm_b32 v44, v39, v39, v4
WP4_22:
    s_cbranch_execz WP4_23
    v_perm_b32 v45, v39, v39, v5
    v_perm_b32 v46, v39, v39, v6
    v_perm_b32 v47, v39, v39, v7
    v_mfma_f32_16x16x32_bf16 v[24:27], v[120:123], v[40:43], v[24:27]
    s_nop 1
    v_mfma_f32_16x16x32_bf16 v[24:27], v[124:127], v[44:47], v[24:27]
    s_waitcnt vmcnt(8)
    buffer_load_dwordx4 v[112:115], v17, s[56:59], s76 offen offset:0 nt
    buffer_load_dwordx4 v[116:119], v17, s[56:59], s90 offen offset:0 nt
WP4_23:
    s_cbranch_execz WP4_24
    buffer_load_dwordx4 v[120:123], v17, s[56:59], s91 offen offset:0 nt
    buffer_load_dwordx4 v[124:127], v17, s[56:59], s92 offen offset:0 nt
    s_add_u32 s76, s76, 32768
    s_and_b32 s76, s76, 2097151
    v_dot2_f32_bf16 v32, v128, v20, 0
    v_dot2_f32_bf16 v33, v132, v20, 0
    v_dot2_f32_bf16 v34, v136, v20, 0
WP4_24:
    s_cbranch_execz WP4_25
    v_dot2_f32_bf16 v35, v140, v20, 0
    v_dot2_f32_bf16 v32, v129, v21, v32
    v_dot2_f32_bf16 v33, v133, v21, v33
    v_dot2_f32_bf16 v34, v137, v21, v34
    v_dot2_f32_bf16 v35, v141, v21, v35
    v_dot2_f32_bf16 v32, v130, v22, v32
    v_dot2_f32_bf16 v33, v134, v22, v33
    v_dot2_f32_bf16 v34, v138, v22, v34
WP4_25:
    s_cbranch_execz WP4_26
    v_dot2_f32_bf16 v35, v142, v22, v35
    v_dot2_f32_bf16 v32, v131, v23, v32
    v_dot2_f32_bf16 v33, v135, v23, v33
    v_dot2_f32_bf16 v34, v139, v23, v34
    v_dot2_f32_bf16 v35, v143, v23, v35
    s_waitcnt vmcnt(8)
    s_add_u32 s90, s76, 4096
    s_add_u32 s91, s76, 8192
WP4_26:
    s_cbranch_execz WP4_27
    s_add_u32 s92, s76, 12288
    buffer_load_dwordx4 v[128:131], v17, s[52:55], s76 offen offset:0 nt
    buffer_load_dwordx4 v[132:135], v17, s[52:55], s90 offen offset:0 nt
    buffer_load_dwordx4 v[136:139], v17, s[52:55], s91 offen offset:0 nt
    buffer_load_dwordx4 v[140:143], v17, s[52:55], s92 offen offset:0 nt
    s_nop 2
    v_add_f32_dpp v30, v32, v32 row_ror:8 row_mask:0xf bank_mask:0xf
    v_add_f32_dpp v31, v33, v33 row_ror:8 row_mask:0xf bank_mask:0xf
WP4_27:
    s_cbranch_execz WP4_28
    v_add_f32_dpp v30, v34, v34 row_ror:8 row_mask:0xf bank_mask:0xc
    v_add_f32_dpp v31, v35, v35 row_ror:8 row_mask:0xf bank_mask:0xc
    s_nop 0
    v_add_f32_dpp v36, v30, v30 row_half_mirror row_mask:0xf bank_mask:0x5
    v_add_f32_dpp v36, v31, v31 row_half_mirror row_mask:0xf bank_mask:0xa
    s_nop 1
    v_add_f32_dpp v36, v36, v36 quad_perm:[1,0,3,2] row_mask:0xf bank_mask:0xf
    s_nop 1
    v_add_f32_dpp v36, v36, v36 quad_perm:[2,3,0,1] row_mask:0xf bank_mask:0xf
WP4_28:
    s_cbranch_execz WP4_29
    v_cvt_pk_bf16_f32 v36, 0, v36
    v_mul_f32 v36, 0x3db504f3, v36
    v_cvt_pk_bf16_f32 v36, 0, v36
    v_cmp_lt_f32 vcc, v28, v36
    s_cbranch_vccnz RESC_5
CONT_6:
    v_fma_f32 v30, v36, v19, v29
    v_exp_f32 v30, v30
    s_nop 0
    v_add_f32 v18, v18, v30
    v_cvt_pk_bf16_f32 v31, 0, v30
WP4_29:
    s_cbranch_execz WP4_30
    v_sub_f32 v31, v30, v31
    v_cvt_pk_bf16_f32 v37, v31, v30
    s_nop 1
    v_mov_b32_dpp v38, v37 row_newbcast:0 row_mask:0xf bank_mask:0xf
    v_perm_b32 v40, v38, v38, v4
    v_perm_b32 v41, v38, v38, v5
    v_perm_b32 v42, v38, v38, v6
    v_perm_b32 v43, v38, v38, v7
WP4_30:
    s_cbranch_execz WP4_31
    v_mov_b32_dpp v39, v37 row_newbcast:4 row_mask:0xf bank_mask:0xf
    v_perm_b32 v44, v39, v39, v4
    v_perm_b32 v45, v39, v39, v5
    v_perm_b32 v46, v39, v39, v6
    v_perm_b32 v47, v39, v39, v7
    v_mfma_f32_16x16x32_bf16 v[24:27], v[144:147], v[40:43], v[24:27]
    v_mov_b32_dpp v38, v37 row_newbcast:8 row_mask:0xf bank_mask:0xf
    v_perm_b32 v40, v38, v38, v4
WP4_31:
    s_cbranch_execz WP4_32
    v_perm_b32 v41, v38, v38, v5
    v_perm_b32 v42, v38, v38, v6
    v_perm_b32 v43, v38, v38, v7
    v_mfma_f32_16x16x32_bf16 v[24:27], v[148:151], v[44:47], v[24:27]
    v_mov_b32_dpp v39, v37 row_newbcast:12 row_mask:0xf bank_mask:0xf
    v_perm_b32 v44, v39, v39, v4
    v_perm_b32 v45, v39, v39, v5
WP4_32:
    s_cbranch_execz WP4_33
    v_perm_b32 v46, v39, v39, v6
    v_perm_b32 v47, v39, v39, v7
    v_mfma_f32_16x16x32_bf16 v[24:27], v[152:155], v[40:43], v[24:27]
    s_nop 1
    v_mfma_f32_16x16x32_bf16 v[24:27], v[156:159], v[44:47], v[24:27]
    s_waitcnt vmcnt(8)
    buffer_load_dwordx4 v[144:147], v17, s[56:59], s76 offen offset:0 nt
    buffer_load_dwordx4 v[148:151], v17, s[56:59], s90 offen offset:0 nt
    buffer_load_dwordx4 v[152:155], v17, s[56:59], s91 offen offset:0 nt
WP4_33:
    s_cbranch_execz WARM_RET2
    buffer_load_dwordx4 v[156:159], v17, s[56:59], s92 offen offset:0 nt
    s_add_u32 s76, s76, 32768
    s_and_b32 s76, s76, 2097151
WP5_0:
    s_cbranch_execz WP5_1
    v_dot2_f32_bf16 v32, v160, v20, 0
    v_dot2_f32_bf16 v33, v164, v20, 0
    v_dot2_f32_bf16 v34, v168, v20, 0
    v_dot2_f32_bf16 v35, v172, v20, 0
WP5_1:
    s_cbranch_execz WP5_2
    v_dot2_f32_bf16 v32, v161, v21, v32
    v_dot2_f32_bf16 v33, v165, v21, v33
    v_dot2_f32_bf16 v34, v169, v21, v34
    v_dot2_f32_bf16 v35, v173, v21, v35
    v_dot2_f32_bf16 v32, v162, v22, v32
    v_dot2_f32_bf16 v33, v166, v22, v33
    v_dot2_f32_bf16 v34, v170, v22, v34
WP5_2:
    s_cbranch_execz WP5_3
    v_dot2_f32_bf16 v35, v174, v22, v35
    v_dot2_f32_bf16 v32, v163, v23, v32
    v_dot2_f32_bf16 v33, v167, v23, v33
    v_dot2_f32_bf16 v34, v171, v23, v34
    v_dot2_f32_bf16 v35, v175, v23, v35
    s_waitcnt vmcnt(8)
    s_add_u32 s90, s76, 4096
    s_add_u32 s91, s76, 8192
WP5_3:
    s_cbranch_execz WP5_4
    s_add_u32 s92, s76, 12288
    buffer_load_dwordx4 v[160:163], v17, s[52:55], s76 offen offset:0 nt
    buffer_load_dwordx4 v[164:167], v17, s[52:55], s90 offen offset:0 nt
    buffer_load_dwordx4 v[168:171], v17, s[52:55], s91 offen offset:0 nt
    buffer_load_dwordx4 v[172:175], v17, s[52:55], s92 offen offset:0 nt
    s_nop 2
    v_add_f32_dpp v30, v32, v32 row_ror:8 row_mask:0xf bank_mask:0xf
    v_add_f32_dpp v31, v33, v33 row_ror:8 row_mask:0xf bank_mask:0xf
WP5_4:
    s_cbranch_execz WP5_5
    v_add_f32_dpp v30, v34, v34 row_ror:8 row_mask:0xf bank_mask:0xc
    v_add_f32_dpp v31, v35, v35 row_ror:8 row_mask:0xf bank_mask:0xc
    s_nop 0
    v_add_f32_dpp v36, v30, v30 row_half_mirror row_mask:0xf bank_mask:0x5
    v_add_f32_dpp v36, v31, v31 row_half_mirror row_mask:0xf bank_mask:0xa
    s_nop 1
    v_add_f32_dpp v36, v36, v36 quad_perm:[1,0,3,2] row_mask:0xf bank_mask:0xf
    s_nop 1
    v_add_f32_dpp v36, v36, v36 quad_perm:[2,3,0,1] row_mask:0xf bank_mask:0xf
WP5_5:
    s_cbranch_execz WP5_6
    v_cvt_pk_bf16_f32 v36, 0, v36
    v_mul_f32 v36, 0x3db504f3, v36
    v_cvt_pk_bf16_f32 v36, 0, v36
    v_cmp_lt_f32 vcc, v28, v36
    s_cbranch_vccnz RESC_7
CONT_8:
    v_fma_f32 v30, v36, v19, v29
    v_exp_f32 v30, v30
    s_nop 0
    v_add_f32 v18, v18, v30
    v_cvt_pk_bf16_f32 v31, 0, v30
WP5_6:
    s_cbranch_execz WP5_7
    v_sub_f32 v31, v30, v31
    v_cvt_pk_bf16_f32 v37, v31, v30
    s_nop 1
    v_mov_b32_dpp v38, v37 row_newbcast:0 row_mask:0xf bank_mask:0xf
    v_perm_b32 v40, v38, v38, v4
    v_perm_b32 v41, v38, v38, v5
    v_perm_b32 v42, v38, v38, v6
    v_perm_b32 v43, v38, v38, v7
    v_mov_b32_dpp v39, v37 row_newbcast:4 row_mask:0xf bank_mask:0xf
WP5_7:
    s_cbranch_execz WP5_8
    v_perm_b32 v44, v39, v39, v4
    v_perm_b32 v45, v39, v39, v5
    v_perm_b32 v46, v39, v39, v6
    v_perm_b32 v47, v39, v39, v7
    v_mfma_f32_16x16x32_bf16 v[24:27], v[176:179], v[40:43], v[24:27]
    v_mov_b32_dpp v38, v37 row_newbcast:8 row_mask:0xf bank_mask:0xf
    v_perm_b32 v40, v38, v38, v4
WP5_8:
    s_cbranch_execz WP5_9
    v_perm_b32 v41, v38, v38, v5
    v_perm_b32 v42, v38, v38, v6
    v_perm_b32 v43, v38, v38, v7
    v_mfma_f32_16x16x32_bf16 v[24:27], v[180:183], v[44:47], v[24:27]
    v_mov_b32_dpp v39, v37 row_newbcast:12 row_mask:0xf bank_mask:0xf
    v_perm_b32 v44, v39, v39, v4
    v_perm_b32 v45, v39, v39, v5
    v_perm_b32 v46, v39, v39, v6
WP5_9:
    s_cbranch_execz WP5_10
    v_perm_b32 v47, v39, v39, v7
    v_mfma_f32_16x16x32_bf16 v[24:27], v[184:187], v[40:43], v[24:27]
    s_nop 1
    v_mfma_f32_16x16x32_bf16 v[24:27], v[188:191], v[44:47], v[24:27]
    s_waitcnt vmcnt(8)
    buffer_load_dwordx4 v[176:179], v17, s[56:59], s76 offen offset:0 nt
    buffer_load_dwordx4 v[180:183], v17, s[56:59], s90 offen offset:0 nt
    buffer_load_dwordx4 v[184:187], v17, s[56:59], s91 offen offset:0 nt
WP5_10:
    s_cbranch_execz WP5_11
    buffer_load_dwordx4 v[188:191], v17, s[56:59], s92 offen offset:0 nt
    s_add_u32 s76, s76, 32768
    s_and_b32 s76, s76, 2097151
    v_dot2_f32_bf16 v32, v192, v20, 0
    v_dot2_f32_bf16 v33, v196, v20, 0
    v_dot2_f32_bf16 v34, v200, v20, 0
    v_dot2_f32_bf16 v35, v204, v20, 0
    v_dot2_f32_bf16 v32, v193, v21, v32
WP5_11:
    s_cbranch_execz WP5_12
    v_dot2_f32_bf16 v33, v197, v21, v33
    v_dot2_f32_bf16 v34, v201, v21, v34
    v_dot2_f32_bf16 v35, v205, v21, v35
    v_dot2_f32_bf16 v32, v194, v22, v32
    v_dot2_f32_bf16 v33, v198, v22, v33
    v_dot2_f32_bf16 v34, v202, v22, v34
    v_dot2_f32_bf16 v35, v206, v22, v35
WP5_12:
    s_cbranch_execz WP5_13
    v_dot2_f32_bf16 v32, v195, v23, v32
    v_dot2_f32_bf16 v33, v199, v23, v33
    v_dot2_f32_bf16 v34, v203, v23, v34
    v_dot2_f32_bf16 v35, v207, v23, v35
    s_waitcnt vmcnt(8)
    s_add_u32 s90, s76, 4096
    s_add_u32 s91, s76, 8192
    s_add_u32 s92, s76, 12288
WP5_13:
    s_cbranch_execz WP5_14
    buffer_load_dwordx4 v[192:195], v17, s[52:55], s76 offen offset:0 nt
    buffer_load_dwordx4 v[196:199], v17, s[52:55], s90 offen offset:0 nt
    buffer_load_dwordx4 v[200:203], v17, s[52:55], s91 offen offset:0 nt
    buffer_load_dwordx4 v[204:207], v17, s[52:55], s92 offen offset:0 nt
    s_nop 2
    v_add_f32_dpp v30, v32, v32 row_ror:8 row_mask:0xf bank_mask:0xf
    v_add_f32_dpp v31, v33, v33 row_ror:8 row_mask:0xf bank_mask:0xf
    v_add_f32_dpp v30, v34, v34 row_ror:8 row_mask:0xf bank_mask:0xc
WP5_14:
    s_cbranch_execz WP5_15
    v_add_f32_dpp v31, v35, v35 row_ror:8 row_mask:0xf bank_mask:0xc
    s_nop 0
    v_add_f32_dpp v36, v30, v30 row_half_mirror row_mask:0xf bank_mask:0x5
    v_add_f32_dpp v36, v31, v31 row_half_mirror row_mask:0xf bank_mask:0xa
    s_nop 1
    v_add_f32_dpp v36, v36, v36 quad_perm:[1,0,3,2] row_mask:0xf bank_mask:0xf
    s_nop 1
    v_add_f32_dpp v36, v36, v36 quad_perm:[2,3,0,1] row_mask:0xf bank_mask:0xf
    v_cvt_pk_bf16_f32 v36, 0, v36
WP5_15:
    s_cbranch_execz WP5_16
    v_mul_f32 v36, 0x3db504f3, v36
    v_cvt_pk_bf16_f32 v36, 0, v36
    v_cmp_lt_f32 vcc, v28, v36
    s_cbranch_vccnz RESC_9
CONT_10:
    v_fma_f32 v30, v36, v19, v29
    v_exp_f32 v30, v30
    s_nop 0
    v_add_f32 v18, v18, v30
    v_cvt_pk_bf16_f32 v31, 0, v30
    v_sub_f32 v31, v30, v31
    v_cvt_pk_bf16_f32 v37, v31, v30
WP5_16:
    s_cbranch_execz WP5_17
    s_nop 1
    v_mov_b32_dpp v38, v37 row_newbcast:0 row_mask:0xf bank_mask:0xf
    v_perm_b32 v40, v38, v38, v4
    v_perm_b32 v41, v38, v38, v5
    v_perm_b32 v42, v38, v38, v6
    v_perm_b32 v43, v38, v38, v7
    v_mov_b32_dpp v39, v37 row_newbcast:4 row_mask:0xf bank_mask:0xf
    v_perm_b32 v44, v39, v39, v4
WP5_17:
    s_cbranch_execz WP5_18
    v_perm_b32 v45, v39, v39, v5
    v_perm_b32 v46, v39, v39, v6
    v_perm_b32 v47, v39, v39, v7
    v_mfma_f32_16x16x32_bf16 v[24:27], v[208:211], v[40:43], v[24:27]
    v_mov_b32_dpp v38, v37 row_newbcast:8 row_mask:0xf bank_mask:0xf
    v_perm_b32 v40, v38, v38, v4
    v_perm_b32 v41, v38, v38, v5
WP5_18:
    s_cbranch_execz WP5_19
    v_perm_b32 v42, v38, v38, v6
    v_perm_b32 v43, v38, v38, v7
    v_mfma_f32_16x16x32_bf16 v[24:27], v[212:215], v[44:47], v[24:27]
    v_mov_b32_dpp v39, v37 row_newbcast:12 row_mask:0xf bank_mask:0xf
    v_perm_b32 v44, v39, v39, v4
    v_perm_b32 v45, v39, v39, v5
    v_perm_b32 v46, v39, v39, v6
    v_perm_b32 v47, v39, v39, v7
WP5_19:
    s_cbranch_execz WP5_20
    v_mfma_f32_16x16x32_bf16 v[24:27], v[216:219], v[40:43], v[24:27]
    s_nop 1
    v_mfma_f32_16x16x32_bf16 v[24:27], v[220:223], v[44:47], v[24:27]
    s_waitcnt vmcnt(8)
    buffer_load_dwordx4 v[208:211], v17, s[56:59], s76 offen offset:0 nt
    buffer_load_dwordx4 v[212:215], v17, s[56:59], s90 offen offset:0 nt
    buffer_load_dwordx4 v[216:219], v17, s[56:59], s91 offen offset:0 nt
    buffer_load_dwordx4 v[220:223], v17, s[56:59], s92 offen offset:0 nt
WP5_20:
    s_cbranch_execz WP5_21
    s_add_u32 s76, s76, 32768
    s_and_b32 s76, s76, 2097151
    v_dot2_f32_bf16 v32, v224, v20, 0
    v_dot2_f32_bf16 v33, v228, v20, 0
    v_dot2_f32_bf16 v34, v232, v20, 0
    v_dot2_f32_bf16 v35, v236, v20, 0
    v_dot2_f32_bf16 v32, v225, v21, v32
    v_dot2_f32_bf16 v33, v229, v21, v33
WP5_21:
    s_cbranch_execz WP5_22
    v_dot2_f32_bf16 v34, v233, v21, v34
    v_dot2_f32_bf16 v35, v237, v21, v35
    v_dot2_f32_bf16 v32, v226, v22, v32
    v_dot2_f32_bf16 v33, v230, v22, v33
    v_dot2_f32_bf16 v34, v234, v22, v34
    v_dot2_f32_bf16 v35, v238, v22, v35
    v_dot2_f32_bf16 v32, v227, v23, v32
WP5_22:
    s_cbranch_execz WP5_23
    v_dot2_f32_bf16 v33, v231, v23, v33
    v_dot2_f32_bf16 v34, v235, v23, v34
    v_dot2_f32_bf16 v35, v239, v23, v35
    s_waitcnt vmcnt(8)
    s_add_u32 s90, s76, 4096
    s_add_u32 s91, s76, 8192
    s_add_u32 s92, s76, 12288
    buffer_load_dwordx4 v[224:227], v17, s[52:55], s76 offen offset:0 nt
WP5_23:
    s_cbranch_execz WP5_24
    buffer_load_dwordx4 v[228:231], v17, s[52:55], s90 offen offset:0 nt
    buffer_load_dwordx4 v[232:235], v17, s[52:55], s91 offen offset:0 nt
    buffer_load_dwordx4 v[236:239], v17, s[52:55], s92 offen offset:0 nt
    s_nop 2
    v_add_f32_dpp v30, v32, v32 row_ror:8 row_mask:0xf bank_mask:0xf
    v_add_f32_dpp v31, v33, v33 row_ror:8 row_mask:0xf bank_mask:0xf
    v_add_f32_dpp v30, v34, v34 row_ror:8 row_mask:0xf bank_mask:0xc
    v_add_f32_dpp v31, v35, v35 row_ror:8 row_mask:0xf bank_mask:0xc
WP5_24:
    s_cbranch_execz WP5_25
    s_nop 0
    v_add_f32_dpp v36, v30, v30 row_half_mirror row_mask:0xf bank_mask:0x5
    v_add_f32_dpp v36, v31, v31 row_half_mirror row_mask:0xf bank_mask:0xa
    s_nop 1
    v_add_f32_dpp v36, v36, v36 quad_perm:[1,0,3,2] row_mask:0xf bank_mask:0xf
    s_nop 1
    v_add_f32_dpp v36, v36, v36 quad_perm:[2,3,0,1] row_mask:0xf bank_mask:0xf
    v_cvt_pk_bf16_f32 v36, 0, v36
    v_mul_f32 v36, 0x3db504f3, v36
WP5_25:
    s_cbranch_execz WP5_26
    v_cvt_pk_bf16_f32 v36, 0, v36
    v_cmp_lt_f32 vcc, v28, v36
    s_cbranch_vccnz RESC_11
CONT_12:
    v_fma_f32 v30, v36, v19, v29
    v_exp_f32 v30, v30
    s_nop 0
    v_add_f32 v18, v18, v30
    v_cvt_pk_bf16_f32 v31, 0, v30
    v_sub_f32 v31, v30, v31
    v_cvt_pk_bf16_f32 v37, v31, v30
    s_nop 1
WP5_26:
    s_cbranch_execz WP5_27
    v_mov_b32_dpp v38, v37 row_newbcast:0 row_mask:0xf bank_mask:0xf
    v_perm_b32 v40, v38, v38, v4
    v_perm_b32 v41, v38, v38, v5
    v_perm_b32 v42, v38, v38, v6
    v_perm_b32 v43, v38, v38, v7
    v_mov_b32_dpp v39, v37 row_newbcast:4 row_mask:0xf bank_mask:0xf
    v_perm_b32 v44, v39, v39, v4
    v_perm_b32 v45, v39, v39, v5
WP5_27:
    s_cbranch_execz WP5_28
    v_perm_b32 v46, v39, v39, v6
    v_perm_b32 v47, v39, v39, v7
    v_mfma_f32_16x16x32_bf16 v[24:27], v[240:243], v[40:43], v[24:27]
    v_mov_b32_dpp v38, v37 row_newbcast:8 row_mask:0xf bank_mask:0xf
    v_perm_b32 v40, v38, v38, v4
    v_perm_b32 v41, v38, v38, v5
    v_perm_b32 v42, v38, v38, v6
WP5_28:
    s_cbranch_execz WP5_29
    v_perm_b32 v43, v38, v38, v7
    v_mfma_f32_16x16x32_bf16 v[24:27], v[244:247], v[44:47], v[24:27]
    v_mov_b32_dpp v39, v37 row_newbcast:12 row_mask:0xf bank_mask:0xf
    v_perm_b32 v44, v39, v39, v4
    v_perm_b32 v45, v39, v39, v5
    v_perm_b32 v46, v39, v39, v6
    v_perm_b32 v47, v39, v39, v7
    v_mfma_f32_16x16x32_bf16 v[24:27], v[248:251], v[40:43], v[24:27]
WP5_29:
    s_cbranch_execz WP5_30
    s_nop 1
    v_mfma_f32_16x16x32_bf16 v[24:27], v[252:255], v[44:47], v[24:27]
    s_waitcnt vmcnt(8)
    buffer_load_dwordx4 v[240:243], v17, s[56:59], s76 offen offset:0 nt
    buffer_load_dwordx4 v[244:247], v17, s[56:59], s90 offen offset:0 nt
    buffer_load_dwordx4 v[248:251], v17, s[56:59], s91 offen offset:0 nt
    buffer_load_dwordx4 v[252:255], v17, s[56:59], s92 offen offset:0 nt
    s_add_u32 s76, s76, 32768
WP5_30:
    s_cbranch_execz WARM_RET2
    s_and_b32 s76, s76, 2097151
    s_sub_u32 s77, s77, 1
    s_cmp_lg_u32 s77, 0
    s_cbranch_scc1 MAINLOOP
WP2_0:
    s_cbranch_execz WP2_1
    s_mov_b32 s64, s28
    s_mov_b32 s65, s29
    s_mov_b32 s66, 1835008
    s_mov_b32 s67, 0x00020000
    s_mov_b32 s68, s30
    s_mov_b32 s69, s31
    s_mov_b32 s70, 1835008
WP2_1:
    s_cbranch_execz WP2_2
    s_mov_b32 s71, 0x00020000
    s_mov_b32 s72, s32
    s_mov_b32 s73, s33
    s_mov_b32 s74, 1835008
    s_mov_b32 s75, 0x00020000
    s_min_u32 s79, s45, 55
    v_lshrrev_b32 v12, 3, v2
    v_lshl_add_u32 v12, v3, 1, v12
    v_mul_u32_u24 v12, 3584, v12
WP2_2:
    s_cbranch_execz WP2_3
    v_and_b32 v13, 3, v2
    v_lshl_add_u32 v13, v13, 4, v12
    s_mul_i32 s80, s86, 458752
    s_lshl_b32 s81, s79, 6
    s_add_u32 s80, s80, s81
    v_lshlrev_b32 v14, 4, v2
    v_lshl_add_u32 v14, v3, 10, v14
    s_lshl_b32 s81, s79, 15
    s_lshl_b32 s82, s86, 8
    s_add_u32 s81, s81, s82
    s_waitcnt vmcnt(44)
    v_dot2_f32_bf16 v32, v64, v20, 0
WP2_3:
    s_cbranch_execz WP2_4
    v_dot2_f32_bf16 v33, v68, v20, 0
    v_dot2_f32_bf16 v34, v72, v20, 0
    v_dot2_f32_bf16 v35, v76, v20, 0
    v_dot2_f32_bf16 v32, v65, v21, v32
    v_dot2_f32_bf16 v33, v69, v21, v33
    v_dot2_f32_bf16 v34, v73, v21, v34
    v_dot2_f32_bf16 v35, v77, v21, v35
WP2_4:
    s_cbranch_execz WP2_5
    v_dot2_f32_bf16 v32, v66, v22, v32
    v_dot2_f32_bf16 v33, v70, v22, v33
    v_dot2_f32_bf16 v34, v74, v22, v34
    v_dot2_f32_bf16 v35, v78, v22, v35
    v_dot2_f32_bf16 v32, v67, v23, v32
    v_dot2_f32_bf16 v33, v71, v23, v33
    v_dot2_f32_bf16 v34, v75, v23, v34
    v_dot2_f32_bf16 v35, v79, v23, v35
WP2_5:
    s_cbranch_execz WP2_6
    s_waitcnt vmcnt(8)
    s_add_u32 s90, s76, 4096
    s_add_u32 s91, s76, 8192
    s_add_u32 s92, s76, 12288
    buffer_load_dwordx4 v[64:67], v17, s[52:55], s76 offen offset:0 nt
    buffer_load_dwordx4 v[68:71], v17, s[52:55], s90 offen offset:0 nt
    buffer_load_dwordx4 v[72:75], v17, s[52:55], s91 offen offset:0 nt
    buffer_load_dwordx4 v[76:79], v17, s[52:55], s92 offen offset:0 nt
WP2_6:
    s_cbranch_execz WP2_7
    s_waitcnt vmcnt(44)
    s_nop 2
    v_add_f32_dpp v30, v32, v32 row_ror:8 row_mask:0xf bank_mask:0xf
    v_add_f32_dpp v31, v33, v33 row_ror:8 row_mask:0xf bank_mask:0xf
    v_add_f32_dpp v30, v34, v34 row_ror:8 row_mask:0xf bank_mask:0xc
    v_add_f32_dpp v31, v35, v35 row_ror:8 row_mask:0xf bank_mask:0xc
    s_nop 0
    v_add_f32_dpp v36, v30, v30 row_half_mirror row_mask:0xf bank_mask:0x5
    v_add_f32_dpp v36, v31, v31 row_half_mirror row_mask:0xf bank_mask:0xa
WP2_7:
    s_cbranch_execz WP2_8
    s_nop 1
    v_add_f32_dpp v36, v36, v36 quad_perm:[1,0,3,2] row_mask:0xf bank_mask:0xf
    s_nop 1
    v_add_f32_dpp v36, v36, v36 quad_perm:[2,3,0,1] row_mask:0xf bank_mask:0xf
    v_cvt_pk_bf16_f32 v36, 0, v36
    v_mul_f32 v36, 0x3db504f3, v36
    v_cvt_pk_bf16_f32 v36, 0, v36
    v_cmp_lt_f32 vcc, v28, v36
    s_cbranch_vccnz RESC_13
CONT_14:
WP2_8:
    s_cbranch_execz WP2_9
    v_fma_f32 v30, v36, v19, v29
    v_exp_f32 v30, v30
    s_nop 0
    v_add_f32 v18, v18, v30
    v_cvt_pk_bf16_f32 v31, 0, v30
    v_sub_f32 v31, v30, v31
    v_cvt_pk_bf16_f32 v37, v31, v30
    s_nop 1
    v_mov_b32_dpp v38, v37 row_newbcast:0 row_mask:0xf bank_mask:0xf
    v_perm_b32 v40, v38, v38, v4
WP2_9:
    s_cbranch_execz WP2_10
    v_perm_b32 v41, v38, v38, v5
    v_perm_b32 v42, v38, v38, v6
    v_perm_b32 v43, v38, v38, v7
    v_mov_b32_dpp v39, v37 row_newbcast:4 row_mask:0xf bank_mask:0xf
    v_perm_b32 v44, v39, v39, v4
    v_perm_b32 v45, v39, v39, v5
    v_perm_b32 v46, v39, v39, v6
    v_perm_b32 v47, v39, v39, v7
WP2_10:
    s_cbranch_execz WP2_11
    v_mfma_f32_16x16x32_bf16 v[24:27], v[80:83], v[40:43], v[24:27]
    v_mov_b32_dpp v38, v37 row_newbcast:8 row_mask:0xf bank_mask:0xf
    v_perm_b32 v40, v38, v38, v4
    v_perm_b32 v41, v38, v38, v5
    v_perm_b32 v42, v38, v38, v6
    v_perm_b32 v43, v38, v38, v7
    v_mfma_f32_16x16x32_bf16 v[24:27], v[84:87], v[44:47], v[24:27]
WP2_11:
    s_cbranch_execz WP2_12
    v_mov_b32_dpp v39, v37 row_newbcast:12 row_mask:0xf bank_mask:0xf
    v_perm_b32 v44, v39, v39, v4
    v_perm_b32 v45, v39, v39, v5
    v_perm_b32 v46, v39, v39, v6
    v_perm_b32 v47, v39, v39, v7
    v_mfma_f32_16x16x32_bf16 v[24:27], v[88:91], v[40:43], v[24:27]
    s_nop 1
    v_mfma_f32_16x16x32_bf16 v[24:27], v[92:95], v[44:47], v[24:27]
WP2_12:
    s_cbranch_execz WP2_13
    s_waitcnt vmcnt(8)
    buffer_load_dwordx4 v[80:83], v17, s[56:59], s76 offen offset:0 nt
    buffer_load_dwordx4 v[84:87], v17, s[56:59], s90 offen offset:0 nt
    buffer_load_dwordx4 v[88:91], v17, s[56:59], s91 offen offset:0 nt
    buffer_load_dwordx4 v[92:95], v17, s[56:59], s92 offen offset:0 nt
    s_add_u32 s76, s76, 32768
    s_and_b32 s76, s76, 2097151
    s_waitcnt vmcnt(44)
    v_dot2_f32_bf16 v32, v96, v20, 0
WP2_13:
    s_cbranch_execz WP2_14
    v_dot2_f32_bf16 v33, v100, v20, 0
    v_dot2_f32_bf16 v34, v104, v20, 0
    v_dot2_f32_bf16 v35, v108, v20, 0
    v_dot2_f32_bf16 v32, v97, v21, v32
    v_dot2_f32_bf16 v33, v101, v21, v33
    v_dot2_f32_bf16 v34, v105, v21, v34
    v_dot2_f32_bf16 v35, v109, v21, v35
WP2_14:
    s_cbranch_execz WP2_15
    v_dot2_f32_bf16 v32, v98, v22, v32
    v_dot2_f32_bf16 v33, v102, v22, v33
    v_dot2_f32_bf16 v34, v106, v22, v34
    v_dot2_f32_bf16 v35, v110, v22, v35
    v_dot2_f32_bf16 v32, v99, v23, v32
    v_dot2_f32_bf16 v33, v103, v23, v33
    v_dot2_f32_bf16 v34, v107, v23, v34
    v_dot2_f32_bf16 v35, v111, v23, v35
WP2_15:
    s_cbranch_execz WP2_16
    s_waitcnt vmcnt(8)
    s_add_u32 s90, s76, 4096
    s_add_u32 s91, s76, 8192
    s_add_u32 s92, s76, 12288
    buffer_load_dwordx4 v[96:99], v17, s[52:55], s76 offen offset:0 nt
    buffer_load_dwordx4 v[100:103], v17, s[52:55], s90 offen offset:0 nt
    buffer_load_dwordx4 v[104:107], v17, s[52:55], s91 offen offset:0 nt
    buffer_load_dwordx4 v[108:111], v17, s[52:55], s92 offen offset:0 nt
WP2_16:
    s_cbranch_execz WP2_17
    s_waitcnt vmcnt(44)
    s_nop 2
    v_add_f32_dpp v30, v32, v32 row_ror:8 row_mask:0xf bank_mask:0xf
    v_add_f32_dpp v31, v33, v33 row_ror:8 row_mask:0xf bank_mask:0xf
    v_add_f32_dpp v30, v34, v34 row_ror:8 row_mask:0xf bank_mask:0xc
    v_add_f32_dpp v31, v35, v35 row_ror:8 row_mask:0xf bank_mask:0xc
    s_nop 0
    v_add_f32_dpp v36, v30, v30 row_half_mirror row_mask:0xf bank_mask:0x5
    v_add_f32_dpp v36, v31, v31 row_half_mirror row_mask:0xf bank_mask:0xa
WP2_17:
    s_cbranch_execz WP2_18
    s_nop 1
    v_add_f32_dpp v36, v36, v36 quad_perm:[1,0,3,2] row_mask:0xf bank_mask:0xf
    s_nop 1
    v_add_f32_dpp v36, v36, v36 quad_perm:[2,3,0,1] row_mask:0xf bank_mask:0xf
    v_cvt_pk_bf16_f32 v36, 0, v36
    v_mul_f32 v36, 0x3db504f3, v36
    v_cvt_pk_bf16_f32 v36, 0, v36
    v_cmp_lt_f32 vcc, v28, v36
    s_cbranch_vccnz RESC_15
CONT_16:
WP2_18:
    s_cbranch_execz WP2_19
    v_fma_f32 v30, v36, v19, v29
    v_exp_f32 v30, v30
    s_nop 0
    v_add_f32 v18, v18, v30
    v_cvt_pk_bf16_f32 v31, 0, v30
    v_sub_f32 v31, v30, v31
    v_cvt_pk_bf16_f32 v37, v31, v30
    s_nop 1
    v_mov_b32_dpp v38, v37 row_newbcast:0 row_mask:0xf bank_mask:0xf
    v_perm_b32 v40, v38, v38, v4
WP2_19:
    s_cbranch_execz WP2_20
    v_perm_b32 v41, v38, v38, v5
    v_perm_b32 v42, v38, v38, v6
    v_perm_b32 v43, v38, v38, v7
    v_mov_b32_dpp v39, v37 row_newbcast:4 row_mask:0xf bank_mask:0xf
    v_perm_b32 v44, v39, v39, v4
    v_perm_b32 v45, v39, v39, v5
    v_perm_b32 v46, v39, v39, v6
    v_perm_b32 v47, v39, v39, v7
WP2_20:
    s_cbranch_execz WP2_21
    v_mfma_f32_16x16x32_bf16 v[24:27], v[112:115], v[40:43], v[24:27]
    v_mov_b32_dpp v38, v37 row_newbcast:8 row_mask:0xf bank_mask:0xf
    v_perm_b32 v40, v38, v38, v4
    v_perm_b32 v41, v38, v38, v5
    v_perm_b32 v42, v38, v38, v6
    v_perm_b32 v43, v38, v38, v7
    v_mfma_f32_16x16x32_bf16 v[24:27], v[116:119], v[44:47], v[24:27]
WP2_21:
    s_cbranch_execz WP2_22
    v_mov_b32_dpp v39, v37 row_newbcast:12 row_mask:0xf bank_mask:0xf
    v_perm_b32 v44, v39, v39, v4
    v_perm_b32 v45, v39, v39, v5
    v_perm_b32 v46, v39, v39, v6
    v_perm_b32 v47, v39, v39, v7
    v_mfma_f32_16x16x32_bf16 v[24:27], v[120:123], v[40:43], v[24:27]
    s_nop 1
    v_mfma_f32_16x16x32_bf16 v[24:27], v[124:127], v[44:47], v[24:27]
WP2_22:
    s_cbranch_execz WP2_23
    s_waitcnt vmcnt(8)
    buffer_load_dwordx4 v[112:115], v17, s[56:59], s76 offen offset:0 nt
    buffer_load_dwordx4 v[116:119], v17, s[56:59], s90 offen offset:0 nt
    buffer_load_dwordx4 v[120:123], v17, s[56:59], s91 offen offset:0 nt
    buffer_load_dwordx4 v[124:127], v17, s[56:59], s92 offen offset:0 nt
    s_add_u32 s76, s76, 32768
    s_and_b32 s76, s76, 2097151
    s_waitcnt vmcnt(44)
    v_dot2_f32_bf16 v32, v128, v20, 0
WP2_23:
    s_cbranch_execz WP2_24
    v_dot2_f32_bf16 v33, v132, v20, 0
    v_dot2_f32_bf16 v34, v136, v20, 0
    v_dot2_f32_bf16 v35, v140, v20, 0
    v_dot2_f32_bf16 v32, v129, v21, v32
    v_dot2_f32_bf16 v33, v133, v21, v33
    v_dot2_f32_bf16 v34, v137, v21, v34
    v_dot2_f32_bf16 v35, v141, v21, v35
WP2_24:
    s_cbranch_execz WP2_25
    v_dot2_f32_bf16 v32, v130, v22, v32
    v_dot2_f32_bf16 v33, v134, v22, v33
    v_dot2_f32_bf16 v34, v138, v22, v34
    v_dot2_f32_bf16 v35, v142, v22, v35
    v_dot2_f32_bf16 v32, v131, v23, v32
    v_dot2_f32_bf16 v33, v135, v23, v33
    v_dot2_f32_bf16 v34, v139, v23, v34
    v_dot2_f32_bf16 v35, v143, v23, v35
WP2_25:
    s_cbranch_execz WP2_26
    s_waitcnt vmcnt(8)
    s_add_u32 s90, s76, 4096
    s_add_u32 s91, s76, 8192
    s_add_u32 s92, s76, 12288
    buffer_load_dwordx4 v[128:131], v17, s[52:55], s76 offen offset:0 nt
    buffer_load_dwordx4 v[132:135], v17, s[52:55], s90 offen offset:0 nt
    buffer_load_dwordx4 v[136:139], v17, s[52:55], s91 offen offset:0 nt
    buffer_load_dwordx4 v[140:143], v17, s[52:55], s92 offen offset:0 nt
WP2_26:
    s_cbranch_execz WP2_27
    s_waitcnt vmcnt(44)
    s_nop 2
    v_add_f32_dpp v30, v32, v32 row_ror:8 row_mask:0xf bank_mask:0xf
    v_add_f32_dpp v31, v33, v33 row_ror:8 row_mask:0xf bank_mask:0xf
    v_add_f32_dpp v30, v34, v34 row_ror:8 row_mask:0xf bank_mask:0xc
    v_add_f32_dpp v31, v35, v35 row_ror:8 row_mask:0xf bank_mask:0xc
    s_nop 0
    v_add_f32_dpp v36, v30, v30 row_half_mirror row_mask:0xf bank_mask:0x5
    v_add_f32_dpp v36, v31, v31 row_half_mirror row_mask:0xf bank_mask:0xa
WP2_27:
    s_cbranch_execz WP2_28
    s_nop 1
    v_add_f32_dpp v36, v36, v36 quad_perm:[1,0,3,2] row_mask:0xf bank_mask:0xf
    s_nop 1
    v_add_f32_dpp v36, v36, v36 quad_perm:[2,3,0,1] row_mask:0xf bank_mask:0xf
    v_cvt_pk_bf16_f32 v36, 0, v36
    v_mul_f32 v36, 0x3db504f3, v36
    v_cvt_pk_bf16_f32 v36, 0, v36
    v_cmp_lt_f32 vcc, v28, v36
    s_cbranch_vccnz RESC_17
CONT_18:
WP2_28:
    s_cbranch_execz WP2_29
    v_fma_f32 v30, v36, v19, v29
    v_exp_f32 v30, v30
    s_nop 0
    v_add_f32 v18, v18, v30
    v_cvt_pk_bf16_f32 v31, 0, v30
    v_sub_f32 v31, v30, v31
    v_cvt_pk_bf16_f32 v37, v31, v30
    s_nop 1
    v_mov_b32_dpp v38, v37 row_newbcast:0 row_mask:0xf bank_mask:0xf
    v_perm_b32 v40, v38, v38, v4
WP2_29:
    s_cbranch_execz WP2_30
    v_perm_b32 v41, v38, v38, v5
    v_perm_b32 v42, v38, v38, v6
    v_perm_b32 v43, v38, v38, v7
    v_mov_b32_dpp v39, v37 row_newbcast:4 row_mask:0xf bank_mask:0xf
    v_perm_b32 v44, v39, v39, v4
    v_perm_b32 v45, v39, v39, v5
    v_perm_b32 v46, v39, v39, v6
    v_perm_b32 v47, v39, v39, v7
WP2_30:
    s_cbranch_execz WP2_31
    v_mfma_f32_16x16x32_bf16 v[24:27], v[144:147], v[40:43], v[24:27]
    v_mov_b32_dpp v38, v37 row_newbcast:8 row_mask:0xf bank_mask:0xf
    v_perm_b32 v40, v38, v38, v4
    v_perm_b32 v41, v38, v38, v5
    v_perm_b32 v42, v38, v38, v6
    v_perm_b32 v43, v38, v38, v7
    v_mfma_f32_16x16x32_bf16 v[24:27], v[148:151], v[44:47], v[24:27]
WP2_31:
    s_cbranch_execz WP2_32
    v_mov_b32_dpp v39, v37 row_newbcast:12 row_mask:0xf bank_mask:0xf
    v_perm_b32 v44, v39, v39, v4
    v_perm_b32 v45, v39, v39, v5
    v_perm_b32 v46, v39, v39, v6
    v_perm_b32 v47, v39, v39, v7
    v_mfma_f32_16x16x32_bf16 v[24:27], v[152:155], v[40:43], v[24:27]
    s_nop 1
    v_mfma_f32_16x16x32_bf16 v[24:27], v[156:159], v[44:47], v[24:27]
WP2_32:
    s_cbranch_execz WP2_33
    s_waitcnt vmcnt(8)
    buffer_load_dwordx4 v[144:147], v17, s[56:59], s76 offen offset:0 nt
    buffer_load_dwordx4 v[148:151], v17, s[56:59], s90 offen offset:0 nt
    buffer_load_dwordx4 v[152:155], v17, s[56:59], s91 offen offset:0 nt
    buffer_load_dwordx4 v[156:159], v17, s[56:59], s92 offen offset:0 nt
    s_add_u32 s76, s76, 32768
    s_and_b32 s76, s76, 2097151
    s_waitcnt vmcnt(44)
    v_dot2_f32_bf16 v32, v160, v20, 0
WP2_33:
    s_cbranch_execz WP2_34
    v_dot2_f32_bf16 v33, v164, v20, 0
    v_dot2_f32_bf16 v34, v168, v20, 0
    v_dot2_f32_bf16 v35, v172, v20, 0
    v_dot2_f32_bf16 v32, v161, v21, v32
    v_dot2_f32_bf16 v33, v165, v21, v33
    v_dot2_f32_bf16 v34, v169, v21, v34
    v_dot2_f32_bf16 v35, v173, v21, v35
WP2_34:
    s_cbranch_execz WP2_35
    v_dot2_f32_bf16 v32, v162, v22, v32
    v_dot2_f32_bf16 v33, v166, v22, v33
    v_dot2_f32_bf16 v34, v170, v22, v34
    v_dot2_f32_bf16 v35, v174, v22, v35
    v_dot2_f32_bf16 v32, v163, v23, v32
    v_dot2_f32_bf16 v33, v167, v23, v33
    v_dot2_f32_bf16 v34, v171, v23, v34
    v_dot2_f32_bf16 v35, v175, v23, v35
WP2_35:
    s_cbranch_execz WP2_36
    s_waitcnt vmcnt(8)
    s_add_u32 s90, s76, 4096
    s_add_u32 s91, s76, 8192
    s_add_u32 s92, s76, 12288
    buffer_load_dwordx4 v[160:163], v17, s[52:55], s76 offen offset:0 nt
    buffer_load_dwordx4 v[164:167], v17, s[52:55], s90 offen offset:0 nt
    buffer_load_dwordx4 v[168:171], v17, s[52:55], s91 offen offset:0 nt
    buffer_load_dwordx4 v[172:175], v17, s[52:55], s92 offen offset:0 nt
WP2_36:
    s_cbranch_execz WP2_37
    s_waitcnt vmcnt(44)
    s_nop 2
    v_add_f32_dpp v30, v32, v32 row_ror:8 row_mask:0xf bank_mask:0xf
    v_add_f32_dpp v31, v33, v33 row_ror:8 row_mask:0xf bank_mask:0xf
    v_add_f32_dpp v30, v34, v34 row_ror:8 row_mask:0xf bank_mask:0xc
    v_add_f32_dpp v31, v35, v35 row_ror:8 row_mask:0xf bank_mask:0xc
    s_nop 0
    v_add_f32_dpp v36, v30, v30 row_half_mirror row_mask:0xf bank_mask:0x5
    v_add_f32_dpp v36, v31, v31 row_half_mirror row_mask:0xf bank_mask:0xa
WP2_37:
    s_cbranch_execz WP2_38
    s_nop 1
    v_add_f32_dpp v36, v36, v36 quad_perm:[1,0,3,2] row_mask:0xf bank_mask:0xf
    s_nop 1
    v_add_f32_dpp v36, v36, v36 quad_perm:[2,3,0,1] row_mask:0xf bank_mask:0xf
    v_cvt_pk_bf16_f32 v36, 0, v36
    v_mul_f32 v36, 0x3db504f3, v36
    v_cvt_pk_bf16_f32 v36, 0, v36
    v_cmp_lt_f32 vcc, v28, v36
    s_cbranch_vccnz RESC_19
CONT_20:
WP2_38:
    s_cbranch_execz WP2_39
    v_fma_f32 v30, v36, v19, v29
    v_exp_f32 v30, v30
    s_nop 0
    v_add_f32 v18, v18, v30
    v_cvt_pk_bf16_f32 v31, 0, v30
    v_sub_f32 v31, v30, v31
    v_cvt_pk_bf16_f32 v37, v31, v30
    s_nop 1
    v_mov_b32_dpp v38, v37 row_newbcast:0 row_mask:0xf bank_mask:0xf
    v_perm_b32 v40, v38, v38, v4
WP2_39:
    s_cbranch_execz WP2_40
    v_perm_b32 v41, v38, v38, v5
    v_perm_b32 v42, v38, v38, v6
    v_perm_b32 v43, v38, v38, v7
    v_mov_b32_dpp v39, v37 row_newbcast:4 row_mask:0xf bank_mask:0xf
    v_perm_b32 v44, v39, v39, v4
    v_perm_b32 v45, v39, v39, v5
    v_perm_b32 v46, v39, v39, v6
    v_perm_b32 v47, v39, v39, v7
WP2_40:
    s_cbranch_execz WP2_41
    v_mfma_f32_16x16x32_bf16 v[24:27], v[176:179], v[40:43], v[24:27]
    v_mov_b32_dpp v38, v37 row_newbcast:8 row_mask:0xf bank_mask:0xf
    v_perm_b32 v40, v38, v38, v4
    v_perm_b32 v41, v38, v38, v5
    v_perm_b32 v42, v38, v38, v6
    v_perm_b32 v43, v38, v38, v7
    v_mfma_f32_16x16x32_bf16 v[24:27], v[180:183], v[44:47], v[24:27]
WP2_41:
    s_cbranch_execz WP2_42
    v_mov_b32_dpp v39, v37 row_newbcast:12 row_mask:0xf bank_mask:0xf
    v_perm_b32 v44, v39, v39, v4
    v_perm_b32 v45, v39, v39, v5
    v_perm_b32 v46, v39, v39, v6
    v_perm_b32 v47, v39, v39, v7
    v_mfma_f32_16x16x32_bf16 v[24:27], v[184:187], v[40:43], v[24:27]
    s_nop 1
    v_mfma_f32_16x16x32_bf16 v[24:27], v[188:191], v[44:47], v[24:27]
WP2_42:
    s_cbranch_execz WP2_43
    s_waitcnt vmcnt(8)
    buffer_load_dwordx4 v[176:179], v17, s[56:59], s76 offen offset:0 nt
    buffer_load_dwordx4 v[180:183], v17, s[56:59], s90 offen offset:0 nt
    buffer_load_dwordx4 v[184:187], v17, s[56:59], s91 offen offset:0 nt
    buffer_load_dwordx4 v[188:191], v17, s[56:59], s92 offen offset:0 nt
    s_add_u32 s76, s76, 32768
    s_and_b32 s76, s76, 2097151
    s_waitcnt vmcnt(44)
    v_dot2_f32_bf16 v32, v192, v20, 0
WP2_43:
    s_cbranch_execz WP2_44
    v_dot2_f32_bf16 v33, v196, v20, 0
    v_dot2_f32_bf16 v34, v200, v20, 0
    v_dot2_f32_bf16 v35, v204, v20, 0
    v_dot2_f32_bf16 v32, v193, v21, v32
    v_dot2_f32_bf16 v33, v197, v21, v33
    v_dot2_f32_bf16 v34, v201, v21, v34
    v_dot2_f32_bf16 v35, v205, v21, v35
WP2_44:
    s_cbranch_execz WP2_45
    v_dot2_f32_bf16 v32, v194, v22, v32
    v_dot2_f32_bf16 v33, v198, v22, v33
    v_dot2_f32_bf16 v34, v202, v22, v34
    v_dot2_f32_bf16 v35, v206, v22, v35
    v_dot2_f32_bf16 v32, v195, v23, v32
    v_dot2_f32_bf16 v33, v199, v23, v33
    v_dot2_f32_bf16 v34, v203, v23, v34
    v_dot2_f32_bf16 v35, v207, v23, v35
WP2_45:
    s_cbranch_execz WP2_46
    s_waitcnt vmcnt(40)
    s_nop 2
    v_add_f32_dpp v30, v32, v32 row_ror:8 row_mask:0xf bank_mask:0xf
    v_add_f32_dpp v31, v33, v33 row_ror:8 row_mask:0xf bank_mask:0xf
    v_add_f32_dpp v30, v34, v34 row_ror:8 row_mask:0xf bank_mask:0xc
    v_add_f32_dpp v31, v35, v35 row_ror:8 row_mask:0xf bank_mask:0xc
    s_nop 0
    v_add_f32_dpp v36, v30, v30 row_half_mirror row_mask:0xf bank_mask:0x5
    v_add_f32_dpp v36, v31, v31 row_half_mirror row_mask:0xf bank_mask:0xa
WP2_46:
    s_cbranch_execz WP2_47
    s_nop 1
    v_add_f32_dpp v36, v36, v36 quad_perm:[1,0,3,2] row_mask:0xf bank_mask:0xf
    s_nop 1
    v_add_f32_dpp v36, v36, v36 quad_perm:[2,3,0,1] row_mask:0xf bank_mask:0xf
    v_cvt_pk_bf16_f32 v36, 0, v36
    v_mul_f32 v36, 0x3db504f3, v36
    v_cvt_pk_bf16_f32 v36, 0, v36
    v_cmp_lt_f32 vcc, v28, v36
    s_cbranch_vccnz RESC_21
CONT_22:
WP2_47:
    s_cbranch_execz WP2_48
    v_fma_f32 v30, v36, v19, v29
    v_exp_f32 v30, v30
    s_nop 0
    v_add_f32 v18, v18, v30
    v_cvt_pk_bf16_f32 v31, 0, v30
    v_sub_f32 v31, v30, v31
    v_cvt_pk_bf16_f32 v37, v31, v30
    s_nop 1
    v_mov_b32_dpp v38, v37 row_newbcast:0 row_mask:0xf bank_mask:0xf
    v_perm_b32 v40, v38, v38, v4
WP2_48:
    s_cbranch_execz WP2_49
    v_perm_b32 v41, v38, v38, v5
    v_perm_b32 v42, v38, v38, v6
    v_perm_b32 v43, v38, v38, v7
    v_mov_b32_dpp v39, v37 row_newbcast:4 row_mask:0xf bank_mask:0xf
    v_perm_b32 v44, v39, v39, v4
    v_perm_b32 v45, v39, v39, v5
    v_perm_b32 v46, v39, v39, v6
    v_perm_b32 v47, v39, v39, v7
WP2_49:
    s_cbranch_execz WP2_50
    v_mfma_f32_16x16x32_bf16 v[24:27], v[208:211], v[40:43], v[24:27]
    v_mov_b32_dpp v38, v37 row_newbcast:8 row_mask:0xf bank_mask:0xf
    v_perm_b32 v40, v38, v38, v4
    v_perm_b32 v41, v38, v38, v5
    v_perm_b32 v42, v38, v38, v6
    v_perm_b32 v43, v38, v38, v7
    v_mfma_f32_16x16x32_bf16 v[24:27], v[212:215], v[44:47], v[24:27]
WP2_50:
    s_cbranch_execz WP2_51
    v_mov_b32_dpp v39, v37 row_newbcast:12 row_mask:0xf bank_mask:0xf
    v_perm_b32 v44, v39, v39, v4
    v_perm_b32 v45, v39, v39, v5
    v_perm_b32 v46, v39, v39, v6
    v_perm_b32 v47, v39, v39, v7
    v_mfma_f32_16x16x32_bf16 v[24:27], v[216:219], v[40:43], v[24:27]
    s_nop 1
    v_mfma_f32_16x16x32_bf16 v[24:27], v[220:223], v[44:47], v[24:27]
WP2_51:
    s_cbranch_execz WP2_52
    s_mov_b32 exec_lo, 0x0f0f0f0f
    s_mov_b32 exec_hi, 0x0f0f0f0f
    s_add_u32 s82, s80, 0
    buffer_load_dwordx4 v[192:195], v13, s[64:67], s82 offen nt
    s_add_u32 s82, s80, 28672
    buffer_load_dwordx4 v[196:199], v13, s[64:67], s82 offen nt
    s_add_u32 s82, s80, 57344
    buffer_load_dwordx4 v[200:203], v13, s[64:67], s82 offen nt
WP2_52:
    s_cbranch_execz WP2_53
    s_add_u32 s82, s80, 86016
    buffer_load_dwordx4 v[204:207], v13, s[64:67], s82 offen nt
    s_add_u32 s82, s80, 114688
    buffer_load_dwordx4 v[208:211], v13, s[64:67], s82 offen nt
    s_add_u32 s82, s80, 143360
    buffer_load_dwordx4 v[212:215], v13, s[64:67], s82 offen nt
    s_add_u32 s82, s80, 172032
    buffer_load_dwordx4 v[216:219], v13, s[64:67], s82 offen nt
WP2_53:
    s_cbranch_execz WP2_54
    s_add_u32 s82, s80, 200704
    buffer_load_dwordx4 v[220:223], v13, s[64:67], s82 offen nt
    s_mov_b32 exec_lo, 0xf0f0f0f0
    s_mov_b32 exec_hi, 0xf0f0f0f0
    s_add_u32 s82, s80, 0
    buffer_load_dwordx4 v[192:195], v13, s[68:71], s82 offen nt
    s_add_u32 s82, s80, 28672
    buffer_load_dwordx4 v[196:199], v13, s[68:71], s82 offen nt
WP2_54:
    s_cbranch_execz WP2_55
    s_add_u32 s82, s80, 57344
    buffer_load_dwordx4 v[200:203], v13, s[68:71], s82 offen nt
    s_add_u32 s82, s80, 86016
    buffer_load_dwordx4 v[204:207], v13, s[68:71], s82 offen nt
    s_add_u32 s82, s80, 114688
    buffer_load_dwordx4 v[208:211], v13, s[68:71], s82 offen nt
    s_add_u32 s82, s80, 143360
WP2_55:
    s_cbranch_execz WARM_RET
    buffer_load_dwordx4 v[212:215], v13, s[68:71], s82 offen nt
    s_add_u32 s82, s80, 172032
    buffer_load_dwordx4 v[216:219], v13, s[68:71], s82 offen nt
    s_add_u32 s82, s80, 200704
    buffer_load_dwordx4 v[220:223], v13, s[68:71], s82 offen nt
    s_mov_b64 exec, -1
WP3_0:
    s_cbranch_execz WP3_1
    s_waitcnt vmcnt(52)
    v_dot2_f32_bf16 v32, v224, v20, 0
WP3_1:
    s_cbranch_execz WP3_2
    v_dot2_f32_bf16 v33, v228, v20, 0
    v_dot2_f32_bf16 v34, v232, v20, 0
    v_dot2_f32_bf16 v35, v236, v20, 0
    v_dot2_f32_bf16 v32, v225, v21, v32
    v_dot2_f32_bf16 v33, v229, v21, v33
    v_dot2_f32_bf16 v34, v233, v21, v34
    v_dot2_f32_bf16 v35, v237, v21, v35
    v_dot2_f32_bf16 v32, v226, v22, v32
WP3_2:
    s_cbranch_execz WP3_3
    v_dot2_f32_bf16 v33, v230, v22, v33
    v_dot2_f32_bf16 v34, v234, v22, v34
    v_dot2_f32_bf16 v35, v238, v22, v35
    v_dot2_f32_bf16 v32, v227, v23, v32
    v_dot2_f32_bf16 v33, v231, v23, v33
    v_dot2_f32_bf16 v34, v235, v23, v34
    v_dot2_f32_bf16 v35, v239, v23, v35
WP3_3:
    s_cbranch_execz WP3_4
    s_waitcnt vmcnt(48)
    s_nop 2
    v_add_f32_dpp v30, v32, v32 row_ror:8 row_mask:0xf bank_mask:0xf
    v_add_f32_dpp v31, v33, v33 row_ror:8 row_mask:0xf bank_mask:0xf
    v_add_f32_dpp v30, v34, v34 row_ror:8 row_mask:0xf bank_mask:0xc
    v_add_f32_dpp v31, v35, v35 row_ror:8 row_mask:0xf bank_mask:0xc
    s_nop 0
    v_add_f32_dpp v36, v30, v30 row_half_mirror row_mask:0xf bank_mask:0x5
    v_add_f32_dpp v36, v31, v31 row_half_mirror row_mask:0xf bank_mask:0xa
WP3_4:
    s_cbranch_execz WP3_5
    s_nop 1
    v_add_f32_dpp v36, v36, v36 quad_perm:[1,0,3,2] row_mask:0xf bank_mask:0xf
    s_nop 1
    v_add_f32_dpp v36, v36, v36 quad_perm:[2,3,0,1] row_mask:0xf bank_mask:0xf
    v_cvt_pk_bf16_f32 v36, 0, v36
    v_mul_f32 v36, 0x3db504f3, v36
    v_cvt_pk_bf16_f32 v36, 0, v36
    v_cmp_lt_f32 vcc, v28, v36
    s_cbranch_vccnz RESC_23
CONT_24:
    v_fma_f32 v30, v36, v19, v29
WP3_5:
    s_cbranch_execz WP3_6
    v_exp_f32 v30, v30
    s_nop 0
    v_add_f32 v18, v18, v30
    v_cvt_pk_bf16_f32 v31, 0, v30
    v_sub_f32 v31, v30, v31
    v_cvt_pk_bf16_f32 v37, v31, v30
    s_nop 1
    v_mov_b32_dpp v38, v37 row_newbcast:0 row_mask:0xf bank_mask:0xf
    v_perm_b32 v40, v38, v38, v4
    v_perm_b32 v41, v38, v38, v5
WP3_6:
    s_cbranch_execz WP3_7
    v_perm_b32 v42, v38, v38, v6
    v_perm_b32 v43, v38, v38, v7
    v_mov_b32_dpp v39, v37 row_newbcast:4 row_mask:0xf bank_mask:0xf
    v_perm_b32 v44, v39, v39, v4
    v_perm_b32 v45, v39, v39, v5
    v_perm_b32 v46, v39, v39, v6
    v_perm_b32 v47, v39, v39, v7
WP3_7:
    s_cbranch_execz WP3_8
    v_mfma_f32_16x16x32_bf16 v[24:27], v[240:243], v[40:43], v[24:27]
    v_mov_b32_dpp v38, v37 row_newbcast:8 row_mask:0xf bank_mask:0xf
    v_perm_b32 v40, v38, v38, v4
    v_perm_b32 v41, v38, v38, v5
    v_perm_b32 v42, v38, v38, v6
    v_perm_b32 v43, v38, v38, v7
    v_mfma_f32_16x16x32_bf16 v[24:27], v[244:247], v[44:47], v[24:27]
    v_mov_b32_dpp v39, v37 row_newbcast:12 row_mask:0xf bank_mask:0xf
WP3_8:
    s_cbranch_execz WP3_9
    v_perm_b32 v44, v39, v39, v4
    v_perm_b32 v45, v39, v39, v5
    v_perm_b32 v46, v39, v39, v6
    v_perm_b32 v47, v39, v39, v7
    v_mfma_f32_16x16x32_bf16 v[24:27], v[248:251], v[40:43], v[24:27]
    s_nop 1
    v_mfma_f32_16x16x32_bf16 v[24:27], v[252:255], v[44:47], v[24:27]
    s_mov_b32 exec_lo, 0x0f0f0f0f
WP3_9:
    s_cbranch_execz WP3_10
    s_mov_b32 exec_hi, 0x0f0f0f0f
    s_add_u32 s82, s80, 229376
    buffer_load_dwordx4 v[224:227], v13, s[64:67], s82 offen nt
    s_add_u32 s82, s80, 258048
    buffer_load_dwordx4 v[228:231], v13, s[64:67], s82 offen nt
    s_add_u32 s82, s80, 286720
    buffer_load_dwordx4 v[232:235], v13, s[64:67], s82 offen nt
WP3_10:
    s_cbranch_execz WP3_11
    s_add_u32 s82, s80, 315392
    buffer_load_dwordx4 v[236:239], v13, s[64:67], s82 offen nt
    s_add_u32 s82, s80, 344064
    buffer_load_dwordx4 v[240:243], v13, s[64:67], s82 offen nt
    s_add_u32 s82, s80, 372736
    buffer_load_dwordx4 v[244:247], v13, s[64:67], s82 offen nt
    s_add_u32 s82, s80, 401408
    buffer_load_dwordx4 v[248:251], v13, s[64:67], s82 offen nt
WP3_11:
    s_cbranch_execz WP3_12
    s_add_u32 s82, s80, 430080
    buffer_load_dwordx4 v[252:255], v13, s[64:67], s82 offen nt
    s_mov_b32 exec_lo, 0xf0f0f0f0
    s_mov_b32 exec_hi, 0xf0f0f0f0
    s_add_u32 s82, s80, 229376
    buffer_load_dwordx4 v[224:227], v13, s[68:71], s82 offen nt
    s_add_u32 s82, s80, 258048
WP3_12:
    s_cbranch_execz WP3_13
    buffer_load_dwordx4 v[228:231], v13, s[68:71], s82 offen nt
    s_add_u32 s82, s80, 286720
    buffer_load_dwordx4 v[232:235], v13, s[68:71], s82 offen nt
    s_add_u32 s82, s80, 315392
    buffer_load_dwordx4 v[236:239], v13, s[68:71], s82 offen nt
    s_add_u32 s82, s80, 344064
    buffer_load_dwordx4 v[240:243], v13, s[68:71], s82 offen nt
    s_add_u32 s82, s80, 372736
WP3_13:
    s_cbranch_execz WP3_14
    buffer_load_dwordx4 v[244:247], v13, s[68:71], s82 offen nt
    s_add_u32 s82, s80, 401408
    buffer_load_dwordx4 v[248:251], v13, s[68:71], s82 offen nt
    s_add_u32 s82, s80, 430080
    buffer_load_dwordx4 v[252:255], v13, s[68:71], s82 offen nt
    s_mov_b64 exec, -1
    s_waitcnt vmcnt(60)
    v_dot2_f32_bf16 v32, v64, v20, 0
WP3_14:
    s_cbranch_execz WP3_15
    v_dot2_f32_bf16 v33, v68, v20, 0
    v_dot2_f32_bf16 v34, v72, v20, 0
    v_dot2_f32_bf16 v35, v76, v20, 0
    v_dot2_f32_bf16 v32, v65, v21, v32
    v_dot2_f32_bf16 v33, v69, v21, v33
    v_dot2_f32_bf16 v34, v73, v21, v34
    v_dot2_f32_bf16 v35, v77, v21, v35
    v_dot2_f32_bf16 v32, v66, v22, v32
WP3_15:
    s_cbranch_execz WP3_16
    v_dot2_f32_bf16 v33, v70, v22, v33
    v_dot2_f32_bf16 v34, v74, v22, v34
    v_dot2_f32_bf16 v35, v78, v22, v35
    v_dot2_f32_bf16 v32, v67, v23, v32
    v_dot2_f32_bf16 v33, v71, v23, v33
    v_dot2_f32_bf16 v34, v75, v23, v34
    v_dot2_f32_bf16 v35, v79, v23, v35
WP3_16:
    s_cbranch_execz WP3_17
    s_waitcnt vmcnt(56)
    s_nop 2
    v_add_f32_dpp v30, v32, v32 row_ror:8 row_mask:0xf bank_mask:0xf
    v_add_f32_dpp v31, v33, v33 row_ror:8 row_mask:0xf bank_mask:0xf
    v_add_f32_dpp v30, v34, v34 row_ror:8 row_mask:0xf bank_mask:0xc
    v_add_f32_dpp v31, v35, v35 row_ror:8 row_mask:0xf bank_mask:0xc
    s_nop 0
    v_add_f32_dpp v36, v30, v30 row_half_mirror row_mask:0xf bank_mask:0x5
    v_add_f32_dpp v36, v31, v31 row_half_mirror row_mask:0xf bank_mask:0xa
WP3_17:
    s_cbranch_execz WP3_18
    s_nop 1
    v_add_f32_dpp v36, v36, v36 quad_perm:[1,0,3,2] row_mask:0xf bank_mask:0xf
    s_nop 1
    v_add_f32_dpp v36, v36, v36 quad_perm:[2,3,0,1] row_mask:0xf bank_mask:0xf
    v_cvt_pk_bf16_f32 v36, 0, v36
    v_mul_f32 v36, 0x3db504f3, v36
    v_cvt_pk_bf16_f32 v36, 0, v36
    v_cmp_lt_f32 vcc, v28, v36
    s_cbranch_vccnz RESC_25
CONT_26:
    v_fma_f32 v30, v36, v19, v29
WP3_18:
    s_cbranch_execz WP3_19
    v_exp_f32 v30, v30
    s_nop 0
    v_add_f32 v18, v18, v30
    v_cvt_pk_bf16_f32 v31, 0, v30
    v_sub_f32 v31, v30, v31
    v_cvt_pk_bf16_f32 v37, v31, v30
    s_nop 1
    v_mov_b32_dpp v38, v37 row_newbcast:0 row_mask:0xf bank_mask:0xf
    v_perm_b32 v40, v38, v38, v4
    v_perm_b32 v41, v38, v38, v5
WP3_19:
    s_cbranch_execz WP3_20
    v_perm_b32 v42, v38, v38, v6
    v_perm_b32 v43, v38, v38, v7
    v_mov_b32_dpp v39, v37 row_newbcast:4 row_mask:0xf bank_mask:0xf
    v_perm_b32 v44, v39, v39, v4
    v_perm_b32 v45, v39, v39, v5
    v_perm_b32 v46, v39, v39, v6
    v_perm_b32 v47, v39, v39, v7
WP3_20:
    s_cbranch_execz WP3_21
    v_mfma_f32_16x16x32_bf16 v[24:27], v[80:83], v[40:43], v[24:27]
    v_mov_b32_dpp v38, v37 row_newbcast:8 row_mask:0xf bank_mask:0xf
    v_perm_b32 v40, v38, v38, v4
    v_perm_b32 v41, v38, v38, v5
    v_perm_b32 v42, v38, v38, v6
    v_perm_b32 v43, v38, v38, v7
    v_mfma_f32_16x16x32_bf16 v[24:27], v[84:87], v[44:47], v[24:27]
    v_mov_b32_dpp v39, v37 row_newbcast:12 row_mask:0xf bank_mask:0xf
WP3_21:
    s_cbranch_execz WP3_22
    v_perm_b32 v44, v39, v39, v4
    v_perm_b32 v45, v39, v39, v5
    v_perm_b32 v46, v39, v39, v6
    v_perm_b32 v47, v39, v39, v7
    v_mfma_f32_16x16x32_bf16 v[24:27], v[88:91], v[40:43], v[24:27]
    s_nop 1
    v_mfma_f32_16x16x32_bf16 v[24:27], v[92:95], v[44:47], v[24:27]
    s_add_u32 s82, s81, 0
WP3_22:
    s_cbranch_execz WP3_23
    buffer_load_dwordx4 v[64:67], v14, s[72:75], s82 offen nt
    s_add_u32 s82, s81, 4096
    buffer_load_dwordx4 v[68:71], v14, s[72:75], s82 offen nt
    s_add_u32 s82, s81, 8192
    buffer_load_dwordx4 v[72:75], v14, s[72:75], s82 offen nt
    s_add_u32 s82, s81, 12288
    buffer_load_dwordx4 v[76:79], v14, s[72:75], s82 offen nt
    s_add_u32 s82, s81, 16384
WP3_23:
    s_cbranch_execz WP3_24
    buffer_load_dwordx4 v[80:83], v14, s[72:75], s82 offen nt
    s_add_u32 s82, s81, 20480
    buffer_load_dwordx4 v[84:87], v14, s[72:75], s82 offen nt
    s_add_u32 s82, s81, 24576
    buffer_load_dwordx4 v[88:91], v14, s[72:75], s82 offen nt
    s_add_u32 s82, s81, 28672
    buffer_load_dwordx4 v[92:95], v14, s[72:75], s82 offen nt
WP3_24:
    s_cbranch_execz WP3_25
    s_waitcnt vmcnt(60)
    v_dot2_f32_bf16 v32, v96, v20, 0
    v_dot2_f32_bf16 v33, v100, v20, 0
    v_dot2_f32_bf16 v34, v104, v20, 0
    v_dot2_f32_bf16 v35, v108, v20, 0
    v_dot2_f32_bf16 v32, v97, v21, v32
    v_dot2_f32_bf16 v33, v101, v21, v33
    v_dot2_f32_bf16 v34, v105, v21, v34
WP3_25:
    s_cbranch_execz WP3_26
    v_dot2_f32_bf16 v35, v109, v21, v35
    v_dot2_f32_bf16 v32, v98, v22, v32
    v_dot2_f32_bf16 v33, v102, v22, v33
    v_dot2_f32_bf16 v34, v106, v22, v34
    v_dot2_f32_bf16 v35, v110, v22, v35
    v_dot2_f32_bf16 v32, v99, v23, v32
    v_dot2_f32_bf16 v33, v103, v23, v33
    v_dot2_f32_bf16 v34, v107, v23, v34
WP3_26:
    s_cbranch_execz WP3_27
    v_dot2_f32_bf16 v35, v111, v23, v35
    s_waitcnt vmcnt(56)
    s_nop 2
    v_add_f32_dpp v30, v32, v32 row_ror:8 row_mask:0xf bank_mask:0xf
    v_add_f32_dpp v31, v33, v33 row_ror:8 row_mask:0xf bank_mask:0xf
    v_add_f32_dpp v30, v34, v34 row_ror:8 row_mask:0xf bank_mask:0xc
    v_add_f32_dpp v31, v35, v35 row_ror:8 row_mask:0xf bank_mask:0xc
    s_nop 0
    v_add_f32_dpp v36, v30, v30 row_half_mirror row_mask:0xf bank_mask:0x5
WP3_27:
    s_cbranch_execz WP3_28
    v_add_f32_dpp v36, v31, v31 row_half_mirror row_mask:0xf bank_mask:0xa
    s_nop 1
    v_add_f32_dpp v36, v36, v36 quad_perm:[1,0,3,2] row_mask:0xf bank_mask:0xf
    s_nop 1
    v_add_f32_dpp v36, v36, v36 quad_perm:[2,3,0,1] row_mask:0xf bank_mask:0xf
    v_cvt_pk_bf16_f32 v36, 0, v36
    v_mul_f32 v36, 0x3db504f3, v36
    v_cvt_pk_bf16_f32 v36, 0, v36
WP3_28:
    s_cbranch_execz WP3_29
    v_cmp_lt_f32 vcc, v28, v36
    s_cbranch_vccnz RESC_27
CONT_28:
    v_fma_f32 v30, v36, v19, v29
    v_exp_f32 v30, v30
    s_nop 0
    v_add_f32 v18, v18, v30
    v_cvt_pk_bf16_f32 v31, 0, v30
    v_sub_f32 v31, v30, v31
    v_cvt_pk_bf16_f32 v37, v31, v30
    s_nop 1
    v_mov_b32_dpp v38, v37 row_newbcast:0 row_mask:0xf bank_mask:0xf
WP3_29:
    s_cbranch_execz WP3_30
    v_perm_b32 v40, v38, v38, v4
    v_perm_b32 v41, v38, v38, v5
    v_perm_b32 v42, v38, v38, v6
    v_perm_b32 v43, v38, v38, v7
    v_mov_b32_dpp v39, v37 row_newbcast:4 row_mask:0xf bank_mask:0xf
    v_perm_b32 v44, v39, v39, v4
    v_perm_b32 v45, v39, v39, v5
    v_perm_b32 v46, v39, v39, v6
WP3_30:
    s_cbranch_execz WP3_31
    v_perm_b32 v47, v39, v39, v7
    v_mfma_f32_16x16x32_bf16 v[24:27], v[112:115], v[40:43], v[24:27]
    v_mov_b32_dpp v38, v37 row_newbcast:8 row_mask:0xf bank_mask:0xf
    v_perm_b32 v40, v38, v38, v4
    v_perm_b32 v41, v38, v38, v5
    v_perm_b32 v42, v38, v38, v6
    v_perm_b32 v43, v38, v38, v7
WP3_31:
    s_cbranch_execz WP3_32
    v_mfma_f32_16x16x32_bf16 v[24:27], v[116:119], v[44:47], v[24:27]
    v_mov_b32_dpp v39, v37 row_newbcast:12 row_mask:0xf bank_mask:0xf
    v_perm_b32 v44, v39, v39, v4
    v_perm_b32 v45, v39, v39, v5
    v_perm_b32 v46, v39, v39, v6
    v_perm_b32 v47, v39, v39, v7
    v_mfma_f32_16x16x32_bf16 v[24:27], v[120:123], v[40:43], v[24:27]
    s_nop 1
WP3_32:
    s_cbranch_execz WP3_33
    v_mfma_f32_16x16x32_bf16 v[24:27], v[124:127], v[44:47], v[24:27]
    s_waitcnt vmcnt(52)
    v_dot2_f32_bf16 v32, v128, v20, 0
    v_dot2_f32_bf16 v33, v132, v20, 0
    v_dot2_f32_bf16 v34, v136, v20, 0
    v_dot2_f32_bf16 v35, v140, v20, 0
    v_dot2_f32_bf16 v32, v129, v21, v32
    v_dot2_f32_bf16 v33, v133, v21, v33
WP3_33:
    s_cbranch_execz WP3_34
    v_dot2_f32_bf16 v34, v137, v21, v34
    v_dot2_f32_bf16 v35, v141, v21, v35
    v_dot2_f32_bf16 v32, v130, v22, v32
    v_dot2_f32_bf16 v33, v134, v22, v33
    v_dot2_f32_bf16 v34, v138, v22, v34
    v_dot2_f32_bf16 v35, v142, v22, v35
    v_dot2_f32_bf16 v32, v131, v23, v32
    v_dot2_f32_bf16 v33, v135, v23, v33
WP3_34:
    s_cbranch_execz WP3_35
    v_dot2_f32_bf16 v34, v139, v23, v34
    v_dot2_f32_bf16 v35, v143, v23, v35
    s_waitcnt vmcnt(48)
    s_nop 2
    v_add_f32_dpp v30, v32, v32 row_ror:8 row_mask:0xf bank_mask:0xf
    v_add_f32_dpp v31, v33, v33 row_ror:8 row_mask:0xf bank_mask:0xf
    v_add_f32_dpp v30, v34, v34 row_ror:8 row_mask:0xf bank_mask:0xc
    v_add_f32_dpp v31, v35, v35 row_ror:8 row_mask:0xf bank_mask:0xc
WP3_35:
    s_cbranch_execz WP3_36
    s_nop 0
    v_add_f32_dpp v36, v30, v30 row_half_mirror row_mask:0xf bank_mask:0x5
    v_add_f32_dpp v36, v31, v31 row_half_mirror row_mask:0xf bank_mask:0xa
    s_nop 1
    v_add_f32_dpp v36, v36, v36 quad_perm:[1,0,3,2] row_mask:0xf bank_mask:0xf
    s_nop 1
    v_add_f32_dpp v36, v36, v36 quad_perm:[2,3,0,1] row_mask:0xf bank_mask:0xf
    v_cvt_pk_bf16_f32 v36, 0, v36
    v_mul_f32 v36, 0x3db504f3, v36
WP3_36:
    s_cbranch_execz WP3_37
    v_cvt_pk_bf16_f32 v36, 0, v36
    v_cmp_lt_f32 vcc, v28, v36
    s_cbranch_vccnz RESC_29
CONT_30:
    v_fma_f32 v30, v36, v19, v29
    v_exp_f32 v30, v30
    s_nop 0
    v_add_f32 v18, v18, v30
    v_cvt_pk_bf16_f32 v31, 0, v30
    v_sub_f32 v31, v30, v31
    v_cvt_pk_bf16_f32 v37, v31, v30
    s_nop 1
WP3_37:
    s_cbranch_execz WP3_38
    v_mov_b32_dpp v38, v37 row_newbcast:0 row_mask:0xf bank_mask:0xf
    v_perm_b32 v40, v38, v38, v4
    v_perm_b32 v41, v38, v38, v5
    v_perm_b32 v42, v38, v38, v6
    v_perm_b32 v43, v38, v38, v7
    v_mov_b32_dpp v39, v37 row_newbcast:4 row_mask:0xf bank_mask:0xf
    v_perm_b32 v44, v39, v39, v4
    v_perm_b32 v45, v39, v39, v5
WP3_38:
    s_cbranch_execz WP3_39
    v_perm_b32 v46, v39, v39, v6
    v_perm_b32 v47, v39, v39, v7
    v_mfma_f32_16x16x32_bf16 v[24:27], v[144:147], v[40:43], v[24:27]
    v_mov_b32_dpp v38, v37 row_newbcast:8 row_mask:0xf bank_mask:0xf
    v_perm_b32 v40, v38, v38, v4
    v_perm_b32 v41, v38, v38, v5
    v_perm_b32 v42, v38, v38, v6
WP3_39:
    s_cbranch_execz WP3_40
    v_perm_b32 v43, v38, v38, v7
    v_mfma_f32_16x16x32_bf16 v[24:27], v[148:151], v[44:47], v[24:27]
    v_mov_b32_dpp v39, v37 row_newbcast:12 row_mask:0xf bank_mask:0xf
    v_perm_b32 v44, v39, v39, v4
    v_perm_b32 v45, v39, v39, v5
    v_perm_b32 v46, v39, v39, v6
    v_perm_b32 v47, v39, v39, v7
    v_mfma_f32_16x16x32_bf16 v[24:27], v[152:155], v[40:43], v[24:27]
WP3_40:
    s_cbranch_execz WP3_41
    s_nop 1
    v_mfma_f32_16x16x32_bf16 v[24:27], v[156:159], v[44:47], v[24:27]
    s_waitcnt vmcnt(44)
    v_dot2_f32_bf16 v32, v160, v20, 0
    v_dot2_f32_bf16 v33, v164, v20, 0
    v_dot2_f32_bf16 v34, v168, v20, 0
    v_dot2_f32_bf16 v35, v172, v20, 0
    v_dot2_f32_bf16 v32, v161, v21, v32
WP3_41:
    s_cbranch_execz WP3_42
    v_dot2_f32_bf16 v33, v165, v21, v33
    v_dot2_f32_bf16 v34, v169, v21, v34
    v_dot2_f32_bf16 v35, v173, v21, v35
    v_dot2_f32_bf16 v32, v162, v22, v32
    v_dot2_f32_bf16 v33, v166, v22, v33
    v_dot2_f32_bf16 v34, v170, v22, v34
    v_dot2_f32_bf16 v35, v174, v22, v35
    v_dot2_f32_bf16 v32, v163, v23, v32
WP3_42:
    s_cbranch_execz WP3_43
    v_dot2_f32_bf16 v33, v167, v23, v33
    v_dot2_f32_bf16 v34, v171, v23, v34
    v_dot2_f32_bf16 v35, v175, v23, v35
    s_waitcnt vmcnt(40)
    s_nop 2
    v_add_f32_dpp v30, v32, v32 row_ror:8 row_mask:0xf bank_mask:0xf
    v_add_f32_dpp v31, v33, v33 row_ror:8 row_mask:0xf bank_mask:0xf
    v_add_f32_dpp v30, v34, v34 row_ror:8 row_mask:0xf bank_mask:0xc
WP3_43:
    s_cbranch_execz WP3_44
    v_add_f32_dpp v31, v35, v35 row_ror:8 row_mask:0xf bank_mask:0xc
    s_nop 0
    v_add_f32_dpp v36, v30, v30 row_half_mirror row_mask:0xf bank_mask:0x5
    v_add_f32_dpp v36, v31, v31 row_half_mirror row_mask:0xf bank_mask:0xa
    s_nop 1
    v_add_f32_dpp v36, v36, v36 quad_perm:[1,0,3,2] row_mask:0xf bank_mask:0xf
    s_nop 1
    v_add_f32_dpp v36, v36, v36 quad_perm:[2,3,0,1] row_mask:0xf bank_mask:0xf
    v_cvt_pk_bf16_f32 v36, 0, v36
WP3_44:
    s_cbranch_execz WP3_45
    v_mul_f32 v36, 0x3db504f3, v36
    v_cvt_pk_bf16_f32 v36, 0, v36
    v_cmp_lt_f32 vcc, v28, v36
    s_cbranch_vccnz RESC_31
CONT_32:
    v_fma_f32 v30, v36, v19, v29
    v_exp_f32 v30, v30
    s_nop 0
    v_add_f32 v18, v18, v30
    v_cvt_pk_bf16_f32 v31, 0, v30
    v_sub_f32 v31, v30, v31
    v_cvt_pk_bf16_f32 v37, v31, v30
WP3_45:
    s_cbranch_execz WP3_46
    s_nop 1
    v_mov_b32_dpp v38, v37 row_newbcast:0 row_mask:0xf bank_mask:0xf
    v_perm_b32 v40, v38, v38, v4
    v_perm_b32 v41, v38, v38, v5
    v_perm_b32 v42, v38, v38, v6
    v_perm_b32 v43, v38, v38, v7
    v_mov_b32_dpp v39, v37 row_newbcast:4 row_mask:0xf bank_mask:0xf
    v_perm_b32 v44, v39, v39, v4
WP3_46:
    s_cbranch_execz WP3_47
    v_perm_b32 v45, v39, v39, v5
    v_perm_b32 v46, v39, v39, v6
    v_perm_b32 v47, v39, v39, v7
    v_mfma_f32_16x16x32_bf16 v[24:27], v[176:179], v[40:43], v[24:27]
    v_mov_b32_dpp v38, v37 row_newbcast:8 row_mask:0xf bank_mask:0xf
    v_perm_b32 v40, v38, v38, v4
    v_perm_b32 v41, v38, v38, v5
WP3_47:
    s_cbranch_execz WP3_48
    v_perm_b32 v42, v38, v38, v6
    v_perm_b32 v43, v38, v38, v7
    v_mfma_f32_16x16x32_bf16 v[24:27], v[180:183], v[44:47], v[24:27]
    v_mov_b32_dpp v39, v37 row_newbcast:12 row_mask:0xf bank_mask:0xf
    v_perm_b32 v44, v39, v39, v4
    v_perm_b32 v45, v39, v39, v5
    v_perm_b32 v46, v39, v39, v6
    v_perm_b32 v47, v39, v39, v7
WP3_48:
    s_cbranch_execz WARM_RET
    v_mfma_f32_16x16x32_bf16 v[24:27], v[184:187], v[40:43], v[24:27]
    s_nop 1
    v_mfma_f32_16x16x32_bf16 v[24:27], v[188:191], v[44:47], v[24:27]
WP1_0:
    s_cbranch_execz WP1_1
    v_mov_b32 v32, v18
    s_nop 1
    v_add_f32_dpp v32, v32, v32 row_ror:8 row_mask:0xf bank_mask:0xf
    s_nop 1
    v_add_f32_dpp v32, v32, v32 row_ror:4 row_mask:0xf bank_mask:0xf
    s_nop 1
WP1_1:
    s_cbranch_execz WP1_2
    v_add_f32_dpp v32, v32, v32 row_ror:2 row_mask:0xf bank_mask:0xf
    s_nop 1
    v_add_f32_dpp v32, v32, v32 row_ror:1 row_mask:0xf bank_mask:0xf
    v_mov_b32 v33, v32
    s_nop 1
    v_permlane16_swap_b32 v32, v33
    s_nop 0
    v_add_f32 v32, v32, v33
    v_mov_b32 v33, v32
    s_nop 1
    v_permlane32_swap_b32 v32, v33
    s_nop 0
    v_add_f32 v32, v32, v33
WP1_2:
    s_cbranch_execz WP1_3
    v_mul_f32 v33, 0.25, v32
    v_mov_b32 v32, v28
    v_add_f32_dpp v36, v24, v24 row_ror:8 row_mask:0xf bank_mask:0xf
    v_add_f32_dpp v37, v25, v25 row_ror:8 row_mask:0xf bank_mask:0xf
    v_add_f32_dpp v38, v26, v26 row_ror:8 row_mask:0xf bank_mask:0xf
    v_add_f32_dpp v39, v27, v27 row_ror:8 row_mask:0xf bank_mask:0xf
    v_lshlrev_b32 v12, 2, v2
    v_lshl_add_u32 v12, v3, 8, v12
    s_lshl_b32 s47, s86, 10
WP1_3:
    s_cbranch_execz WP1_4
    v_add_u32 v15, s47, v12
    ds_write_b32 v15, v36 offset:4096
    ds_write_b32 v15, v37 offset:4160
    ds_write_b32 v15, v38 offset:4224
    ds_write_b32 v15, v39 offset:4288
    s_lshl_b32 s47, s86, 3
    v_mov_b32 v12, s47
    ds_write_b64 v12, v[32:33] offset:18432
    s_waitcnt lgkmcnt(0)
    s_barrier
WP1_4:
    s_cbranch_execz WP1_5
    s_cmp_ge_u32 s45, 56
    s_cbranch_scc1 ABORT
    v_bfe_u32 v20, v1, 1, 4
    v_and_b32 v21, 1, v1
    v_lshrrev_b32 v22, 5, v1
    v_lshl_add_u32 v21, v21, 1, v22
    v_lshrrev_b32 v22, 2, v20
    v_lshl_add_u32 v21, v22, 2, v21
    v_and_b32 v20, 3, v20
    v_lshl_add_u32 v22, v21, 2, v20
    s_lshl_b32 s47, s86, 6
WP1_5:
    s_cbranch_execz WP1_6
    v_add_u32 v22, s47, v22
    v_lshlrev_b32 v22, 3, v22
    ds_read_b64 v[24:25], v22 offset:16384
    v_lshlrev_b32 v22, 7, v20
    v_lshl_add_u32 v22, v21, 2, v22
    s_lshl_b32 s47, s86, 9
    v_add_u32 v22, s47, v22
    v_lshrrev_b32 v23, 3, v2
    v_lshl_add_u32 v23, v3, 1, v23
    v_lshlrev_b32 v23, 6, v23
    v_add_u32 v23, s47, v23
    v_lshlrev_b32 v20, 4, v1
WP1_6:
    s_cbranch_execz WP1_7
    v_and_b32 v21, 31, v1
    v_lshlrev_b32 v21, 4, v21
    s_lshl_b32 s47, s86, 9
    v_add_u32 v21, s47, v21
    s_lshl_b32 s50, s44, 11
    s_add_u32 s50, s50, 73728
    v_cmp_lt_u32 s[88:89], 31, v1
    s_waitcnt lgkmcnt(0)
    s_barrier
    s_mov_b32 s78, 100000
POLL_33:
    buffer_load_dwordx4 v[28:31], v20, s[60:63], s50 offen offset:0 sc1
WP1_7:
    s_cbranch_execz WP1_8
    buffer_load_dwordx4 v[32:35], v20, s[60:63], s50 offen offset:1024 sc1
    buffer_load_dwordx4 v[36:39], v21, s[60:63], s50 offen offset:0 sc1
    s_sub_u32 s78, s78, 1
    s_cbranch_scc1 ABORT
    s_waitcnt vmcnt(0)
    v_xor_b32 v26, s48, v30
    v_xor_b32 v27, s49, v31
    v_or_b32 v26, v26, v27
    v_xor_b32 v27, s48, v34
    v_or_b32 v26, v26, v27
    v_xor_b32 v27, s49, v35
    v_or_b32 v26, v26, v27
    v_xor_b32 v27, s48, v38
WP1_8:
    s_cbranch_execz WP1_9
    v_or_b32 v26, v26, v27
    v_xor_b32 v27, s49, v39
    v_or_b32 v26, v26, v27
    v_cmp_ne_u32 vcc, 0, v26
    s_and_b64 exec, exec, vcc
    s_cbranch_execnz POLL_33
    s_mov_b64 exec, -1
    v_lshlrev_b32 v40, 16, v28
    v_and_b32 v41, 0xffff0000, v28
    v_lshlrev_b32 v42, 16, v29
    v_and_b32 v43, 0xffff0000, v29
    v_lshlrev_b32 v44, 16, v32
    v_and_b32 v45, 0xffff0000, v32
WP1_9:
    s_cbranch_execz WP1_10
    v_lshlrev_b32 v46, 16, v33
    v_and_b32 v47, 0xffff0000, v33
    v_cndmask_b32 v36, v36, v37, s[88:89]
    v_lshlrev_b32 v26, 16, v36
    v_and_b32 v27, 0xffff0000, v36
    v_readfirstlane_b32 s47, v40
    s_nop 1
    v_subrev_f32 v40, s47, v40
    v_subrev_f32 v41, s47, v41
    v_subrev_f32 v42, s47, v42
    v_subrev_f32 v43, s47, v43
WP1_10:
    s_cbranch_execz WP1_11
    v_subrev_f32 v44, s47, v44
    v_subrev_f32 v45, s47, v45
    v_subrev_f32 v46, s47, v46
    v_subrev_f32 v47, s47, v47
    v_add_f32 v52, v40, v41
    v_mul_f32 v53, v40, v40
    v_fmac_f32 v53, v41, v41
    v_add_f32 v52, v52, v42
    v_fmac_f32 v53, v42, v42
    v_add_f32 v52, v52, v43
    v_fmac_f32 v53, v43, v43
    v_add_f32 v52, v52, v44
    v_fmac_f32 v53, v44, v44
    v_add_f32 v52, v52, v45
    v_fmac_f32 v53, v45, v45
WP1_11:
    s_cbranch_execz WP1_12
    v_add_f32 v52, v52, v46
    v_fmac_f32 v53, v46, v46
    v_add_f32 v52, v52, v47
    v_fmac_f32 v53, v47, v47
    s_nop 0
    v_add_f32_dpp v52, v52, v52 row_ror:8 row_mask:0xf bank_mask:0xf
    v_add_f32_dpp v53, v53, v53 row_ror:8 row_mask:0xf bank_mask:0xf
    s_nop 0
    v_add_f32_dpp v52, v52, v52 row_ror:4 row_mask:0xf bank_mask:0xf
    v_add_f32_dpp v53, v53, v53 row_ror:4 row_mask:0xf bank_mask:0xf
    s_nop 0
WP1_12:
    s_cbranch_execz WP1_13
    v_add_f32_dpp v52, v52, v52 row_ror:2 row_mask:0xf bank_mask:0xf
    v_add_f32_dpp v53, v53, v53 row_ror:2 row_mask:0xf bank_mask:0xf
    s_nop 0
    v_add_f32_dpp v52, v52, v52 row_ror:1 row_mask:0xf bank_mask:0xf
    v_add_f32_dpp v53, v53, v53 row_ror:1 row_mask:0xf bank_mask:0xf
    v_mov_b32 v54, v52
    v_mov_b32 v55, v53
    s_nop 1
    v_permlane16_swap_b32 v52, v54
    v_permlane16_swap_b32 v53, v55
    s_nop 0
WP1_13:
    s_cbranch_execz WP1_14
    v_add_f32 v52, v52, v54
    v_add_f32 v53, v53, v55
    v_mov_b32 v54, v52
    v_mov_b32 v55, v53
    s_nop 1
    v_permlane32_swap_b32 v52, v54
    v_permlane32_swap_b32 v53, v55
    s_nop 0
    v_add_f32 v52, v52, v54
    v_add_f32 v53, v53, v55
    v_mul_f32 v52, 0x3b000000, v52
    v_mul_f32 v53, 0x3b000000, v53
    v_fma_f32 v53, -v52, v52, v53
WP1_14:
    s_cbranch_execz WP1_15
    v_max_f32 v53, 0, v53
    v_add_f32 v52, s47, v52
    v_cvt_pk_bf16_f32 v53, 0, v53
    v_cvt_pk_bf16_f32 v52, 0, v52
    v_add_f32 v53, 0x3727c5ac, v53
    v_cvt_pk_bf16_f32 v53, 0, v53
    v_sqrt_f32 v53, v53
    s_nop 0
    v_cvt_pk_bf16_f32 v53, 0, v53
WP1_15:
    s_cbranch_execz WP1_16
    v_rcp_f32 v54, v53
    s_nop 0
    v_sub_f32 v26, v26, v52
    v_cvt_pk_bf16_f32 v26, 0, v26
    v_mul_f32 v28, v26, v54
    v_fma_f32 v26, -v28, v53, v26
    v_fma_f32 v26, v26, v54, v28
    v_cvt_pk_bf16_f32 v26, 0, v26
    v_sub_f32 v27, v27, v52
    v_cvt_pk_bf16_f32 v27, 0, v27
WP1_16:
    s_cbranch_execz WP1_17
    v_mul_f32 v28, v27, v54
    v_fma_f32 v27, -v28, v53, v27
    v_fma_f32 v27, v27, v54, v28
    v_cvt_pk_bf16_f32 v27, 0, v27
    v_lshlrev_b32 v28, 16, v24
    v_and_b32 v29, 0xffff0000, v24
    v_lshlrev_b32 v30, 16, v25
    v_and_b32 v31, 0xffff0000, v25
    v_mul_f32 v26, v26, v28
    v_mul_f32 v27, v27, v29
WP1_17:
    s_cbranch_execz WP1_18
    v_cvt_pk_bf16_f32 v26, 0, v26
    v_cvt_pk_bf16_f32 v27, 0, v27
    v_add_f32 v26, v26, v30
    v_add_f32 v27, v27, v31
    v_cvt_pk_bf16_f32 v26, v26, v26
    v_cvt_pk_bf16_f32 v27, v27, v27
    ds_write_b32 v22, v26 offset:12288
    ds_write_b32 v22, v27 offset:12352
    s_waitcnt lgkmcnt(0)
WP1_18:
    s_cbranch_execz WP1_19
    ds_read_b128 v[28:31], v23 offset:12288
    ds_read_b128 v[32:35], v23 offset:12304
    ds_read_b128 v[36:39], v23 offset:12320
    ds_read_b128 v[40:43], v23 offset:12336
    s_waitcnt vmcnt(0) lgkmcnt(0)
    v_and_b32 v52, v28, v8
    v_and_b32 v53, v28, v9
    v_and_b32 v54, v28, v10
    v_and_b32 v55, v28, v11
    v_and_b32 v56, v29, v8
    v_and_b32 v57, v29, v9
WP1_19:
    s_cbranch_execz WP1_20
    v_and_b32 v58, v29, v10
    v_and_b32 v59, v29, v11
    v_mfma_f32_16x16x32_bf16 v[44:47], v[192:195], v[52:55], 0
    v_and_b32 v52, v30, v8
    v_and_b32 v53, v30, v9
    v_and_b32 v54, v30, v10
    v_and_b32 v55, v30, v11
    v_mfma_f32_16x16x32_bf16 v[44:47], v[196:199], v[56:59], v[44:47]
    v_and_b32 v56, v31, v8
    v_and_b32 v57, v31, v9
    v_and_b32 v58, v31, v10
    v_and_b32 v59, v31, v11
    v_mfma_f32_16x16x32_bf16 v[44:47], v[200:203], v[52:55], v[44:47]
WP1_20:
    s_cbranch_execz WP1_21
    v_and_b32 v52, v32, v8
    v_and_b32 v53, v32, v9
    v_and_b32 v54, v32, v10
    v_and_b32 v55, v32, v11
    v_mfma_f32_16x16x32_bf16 v[44:47], v[204:207], v[56:59], v[44:47]
    v_and_b32 v56, v33, v8
    v_and_b32 v57, v33, v9
    v_and_b32 v58, v33, v10
    v_and_b32 v59, v33, v11
    v_mfma_f32_16x16x32_bf16 v[44:47], v[208:211], v[52:55], v[44:47]
    v_and_b32 v52, v34, v8
    v_and_b32 v53, v34, v9
WP1_21:
    s_cbranch_execz WP1_22
    v_and_b32 v54, v34, v10
    v_and_b32 v55, v34, v11
    v_mfma_f32_16x16x32_bf16 v[44:47], v[212:215], v[56:59], v[44:47]
    v_and_b32 v56, v35, v8
    v_and_b32 v57, v35, v9
    v_and_b32 v58, v35, v10
    v_and_b32 v59, v35, v11
    v_mfma_f32_16x16x32_bf16 v[44:47], v[216:219], v[52:55], v[44:47]
    v_and_b32 v52, v36, v8
    v_and_b32 v53, v36, v9
    v_and_b32 v54, v36, v10
    v_and_b32 v55, v36, v11
    v_mfma_f32_16x16x32_bf16 v[44:47], v[220:223], v[56:59], v[44:47]
WP1_22:
    s_cbranch_execz WP1_23
    v_and_b32 v56, v37, v8
    v_and_b32 v57, v37, v9
    v_and_b32 v58, v37, v10
    v_and_b32 v59, v37, v11
    v_mfma_f32_16x16x32_bf16 v[44:47], v[224:227], v[52:55], v[44:47]
    v_and_b32 v52, v38, v8
    v_and_b32 v53, v38, v9
    v_and_b32 v54, v38, v10
    v_and_b32 v55, v38, v11
    v_mfma_f32_16x16x32_bf16 v[44:47], v[228:231], v[56:59], v[44:47]
    v_and_b32 v56, v39, v8
    v_and_b32 v57, v39, v9
WP1_23:
    s_cbranch_execz WP1_24
    v_and_b32 v58, v39, v10
    v_and_b32 v59, v39, v11
    v_mfma_f32_16x16x32_bf16 v[44:47], v[232:235], v[52:55], v[44:47]
    v_and_b32 v52, v40, v8
    v_and_b32 v53, v40, v9
    v_and_b32 v54, v40, v10
    v_and_b32 v55, v40, v11
    v_mfma_f32_16x16x32_bf16 v[44:47], v[236:239], v[56:59], v[44:47]
    v_and_b32 v56, v41, v8
    v_and_b32 v57, v41, v9
    v_and_b32 v58, v41, v10
    v_and_b32 v59, v41, v11
    v_mfma_f32_16x16x32_bf16 v[44:47], v[240:243], v[52:55], v[44:47]
WP1_24:
    s_cbranch_execz WP1_25
    v_and_b32 v52, v42, v8
    v_and_b32 v53, v42, v9
    v_and_b32 v54, v42, v10
    v_and_b32 v55, v42, v11
    v_mfma_f32_16x16x32_bf16 v[44:47], v[244:247], v[56:59], v[44:47]
    v_and_b32 v56, v43, v8
    v_and_b32 v57, v43, v9
    v_and_b32 v58, v43, v10
    v_and_b32 v59, v43, v11
    v_mfma_f32_16x16x32_bf16 v[44:47], v[248:251], v[52:55], v[44:47]
    s_nop 1
    v_mfma_f32_16x16x32_bf16 v[44:47], v[252:255], v[56:59], v[44:47]
WP1_25:
    s_cbranch_execz WP1_26
    v_bfe_u32 v20, v1, 3, 2
    v_lshlrev_b32 v20, 6, v20
    v_and_b32 v21, 7, v1
    v_lshl_add_u32 v20, v21, 2, v20
    v_lshrrev_b32 v21, 5, v1
    v_lshl_add_u32 v20, v21, 8, v20
    v_and_b32 v21, 3, v1
    v_lshlrev_b32 v21, 5, v21
    v_bfe_u32 v22, v1, 2, 3
    v_lshl_add_u32 v21, v22, 2, v21
WP1_26:
    s_cbranch_execz WP1_27
    s_lshl_b32 s47, s86, 7
    v_add_u32 v21, s47, v21
    v_lshlrev_b32 v22, 5, v3
    v_add_u32 v22, s47, v22
    ds_write_b32 v15, v44 offset:8192
    ds_write_b32 v15, v45 offset:8256
    ds_write_b32 v15, v46 offset:8320
    ds_write_b32 v15, v47 offset:8384
    s_waitcnt lgkmcnt(0)
    s_barrier
WP1_27:
    s_cbranch_execz WP1_28
    ds_read_b32 v28, v20 offset:8192
    ds_read_b32 v29, v20 offset:8736
    ds_read_b32 v30, v20 offset:9216
    ds_read_b32 v31, v20 offset:9760
    ds_read_b32 v32, v20 offset:10240
    ds_read_b32 v33, v20 offset:10784
    ds_read_b32 v34, v20 offset:11264
    ds_read_b32 v35, v20 offset:11808
WP1_28:
    s_cbranch_execz WP1_29
    s_waitcnt lgkmcnt(0)
    v_add_f32 v28, v28, v32
    v_add_f32 v29, v29, v33
    v_add_f32 v30, v30, v34
    v_add_f32 v31, v31, v35
    v_add_f32 v28, v28, v29
    v_add_f32 v30, v30, v31
    v_add_f32 v28, v28, v30
    v_cvt_pk_bf16_f32 v28, 0, v28
    v_mov_b32 v29, v28
    s_nop 1
    v_permlane32_swap_b32 v28, v29
    s_nop 0
WP1_29:
    s_cbranch_execz WP1_30
    v_mul_f32 v28, 0xbfb8aa3b, v28
    v_exp_f32 v28, v28
    s_nop 0
    v_add_f32 v28, 1.0, v28
    v_rcp_f32 v28, v28
    s_nop 0
    v_cvt_pk_bf16_f32 v28, 0, v28
    v_mul_f32 v28, v28, v29
    v_cvt_pk_bf16_f32 v28, v28, v28
    ds_write_b32 v21, v28 offset:14336
    s_waitcnt lgkmcnt(0)
WP1_30:
    s_cbranch_execz WP1_31
    ds_read_b128 v[28:31], v22 offset:14336
    ds_read_b128 v[32:35], v22 offset:14352
    s_waitcnt lgkmcnt(0)
    v_and_b32 v52, v28, v8
    v_and_b32 v53, v28, v9
    v_and_b32 v54, v28, v10
    v_and_b32 v55, v28, v11
    v_and_b32 v56, v29, v8
    v_and_b32 v57, v29, v9
    v_and_b32 v58, v29, v10
    v_and_b32 v59, v29, v11
    v_mfma_f32_16x16x32_bf16 v[44:47], v[64:67], v[52:55], 0
WP1_31:
    s_cbranch_execz WP1_32
    v_and_b32 v52, v30, v8
    v_and_b32 v53, v30, v9
    v_and_b32 v54, v30, v10
    v_and_b32 v55, v30, v11
    v_mfma_f32_16x16x32_bf16 v[44:47], v[68:71], v[56:59], v[44:47]
    v_and_b32 v56, v31, v8
    v_and_b32 v57, v31, v9
    v_and_b32 v58, v31, v10
    v_and_b32 v59, v31, v11
    v_mfma_f32_16x16x32_bf16 v[44:47], v[72:75], v[52:55], v[44:47]
    v_and_b32 v52, v32, v8
    v_and_b32 v53, v32, v9
    v_and_b32 v54, v32, v10
WP1_32:
    s_cbranch_execz WP1_33
    v_and_b32 v55, v32, v11
    v_mfma_f32_16x16x32_bf16 v[44:47], v[76:79], v[56:59], v[44:47]
    v_and_b32 v56, v33, v8
    v_and_b32 v57, v33, v9
    v_and_b32 v58, v33, v10
    v_and_b32 v59, v33, v11
    v_mfma_f32_16x16x32_bf16 v[44:47], v[80:83], v[52:55], v[44:47]
    v_and_b32 v52, v34, v8
    v_and_b32 v53, v34, v9
    v_and_b32 v54, v34, v10
    v_and_b32 v55, v34, v11
    v_mfma_f32_16x16x32_bf16 v[44:47], v[84:87], v[56:59], v[44:47]
WP1_33:
    s_cbranch_execz WP1_34
    v_and_b32 v56, v35, v8
    v_and_b32 v57, v35, v9
    v_and_b32 v58, v35, v10
    v_and_b32 v59, v35, v11
    v_mfma_f32_16x16x32_bf16 v[44:47], v[88:91], v[52:55], v[44:47]
    s_nop 1
    v_mfma_f32_16x16x32_bf16 v[44:47], v[92:95], v[56:59], v[44:47]
    s_nop 7
    v_mov_b32 v48, v44
    v_mov_b32 v49, v45
    v_mov_b32_dpp v48, v46 quad_perm:[0,1,2,3] row_mask:0xf bank_mask:0xc
    v_mov_b32_dpp v49, v47 quad_perm:[0,1,2,3] row_mask:0xf bank_mask:0xc
WP1_34:
    s_cbranch_execz WARM_RET
    s_mov_b32 s47, 2097152
    buffer_store_dwordx4 v[48:51], v16, s[60:63], s47 offen sc1
    s_endpgm
RESC_1:
    v_max_f32_dpp v30, v36, v36 row_ror:8 row_mask:0xf bank_mask:0xf
    s_nop 1
    v_max_f32_dpp v30, v30, v30 row_ror:4 row_mask:0xf bank_mask:0xf
    s_nop 1
    v_max_f32_dpp v30, v30, v30 row_bcast:15 row_mask:0xa bank_mask:0xf
    s_nop 1
    v_max_f32_dpp v30, v30, v30 row_bcast:31 row_mask:0xc bank_mask:0xf
    s_nop 0
    v_readlane_b32 s47, v30, 63
    s_nop 1
    v_subrev_f32 v30, s47, v28
    v_mul_f32 v30, v19, v30
    v_exp_f32 v30, v30
    v_mov_b32 v28, s47
    v_mul_f32 v29, 0xbfb8aa3b, v28
    v_mul_f32 v18, v18, v30
    v_mul_f32 v24, v24, v30
    v_mul_f32 v25, v25, v30
    v_mul_f32 v26, v26, v30
    v_mul_f32 v27, v27, v30
    s_branch CONT_2
RESC_3:
    v_max_f32_dpp v30, v36, v36 row_ror:8 row_mask:0xf bank_mask:0xf
    s_nop 1
    v_max_f32_dpp v30, v30, v30 row_ror:4 row_mask:0xf bank_mask:0xf
    s_nop 1
    v_max_f32_dpp v30, v30, v30 row_bcast:15 row_mask:0xa bank_mask:0xf
    s_nop 1
    v_max_f32_dpp v30, v30, v30 row_bcast:31 row_mask:0xc bank_mask:0xf
    s_nop 0
    v_readlane_b32 s47, v30, 63
    s_nop 1
    v_subrev_f32 v30, s47, v28
    v_mul_f32 v30, v19, v30
    v_exp_f32 v30, v30
    v_mov_b32 v28, s47
    v_mul_f32 v29, 0xbfb8aa3b, v28
    v_mul_f32 v18, v18, v30
    v_mul_f32 v24, v24, v30
    v_mul_f32 v25, v25, v30
    v_mul_f32 v26, v26, v30
    v_mul_f32 v27, v27, v30
    s_branch CONT_4
RESC_5:
    v_max_f32_dpp v30, v36, v36 row_ror:8 row_mask:0xf bank_mask:0xf
    s_nop 1
    v_max_f32_dpp v30, v30, v30 row_ror:4 row_mask:0xf bank_mask:0xf
    s_nop 1
    v_max_f32_dpp v30, v30, v30 row_bcast:15 row_mask:0xa bank_mask:0xf
    s_nop 1
    v_max_f32_dpp v30, v30, v30 row_bcast:31 row_mask:0xc bank_mask:0xf
    s_nop 0
    v_readlane_b32 s47, v30, 63
    s_nop 1
    v_subrev_f32 v30, s47, v28
    v_mul_f32 v30, v19, v30
    v_exp_f32 v30, v30
    v_mov_b32 v28, s47
    v_mul_f32 v29, 0xbfb8aa3b, v28
    v_mul_f32 v18, v18, v30
    v_mul_f32 v24, v24, v30
    v_mul_f32 v25, v25, v30
    v_mul_f32 v26, v26, v30
    v_mul_f32 v27, v27, v30
    s_branch CONT_6
RESC_7:
    v_max_f32_dpp v30, v36, v36 row_ror:8 row_mask:0xf bank_mask:0xf
    s_nop 1
    v_max_f32_dpp v30, v30, v30 row_ror:4 row_mask:0xf bank_mask:0xf
    s_nop 1
    v_max_f32_dpp v30, v30, v30 row_bcast:15 row_mask:0xa bank_mask:0xf
    s_nop 1
    v_max_f32_dpp v30, v30, v30 row_bcast:31 row_mask:0xc bank_mask:0xf
    s_nop 0
    v_readlane_b32 s47, v30, 63
    s_nop 1
    v_subrev_f32 v30, s47, v28
    v_mul_f32 v30, v19, v30
    v_exp_f32 v30, v30
    v_mov_b32 v28, s47
    v_mul_f32 v29, 0xbfb8aa3b, v28
    v_mul_f32 v18, v18, v30
    v_mul_f32 v24, v24, v30
    v_mul_f32 v25, v25, v30
    v_mul_f32 v26, v26, v30
    v_mul_f32 v27, v27, v30
    s_branch CONT_8
RESC_9:
    v_max_f32_dpp v30, v36, v36 row_ror:8 row_mask:0xf bank_mask:0xf
    s_nop 1
    v_max_f32_dpp v30, v30, v30 row_ror:4 row_mask:0xf bank_mask:0xf
    s_nop 1
    v_max_f32_dpp v30, v30, v30 row_bcast:15 row_mask:0xa bank_mask:0xf
    s_nop 1
    v_max_f32_dpp v30, v30, v30 row_bcast:31 row_mask:0xc bank_mask:0xf
    s_nop 0
    v_readlane_b32 s47, v30, 63
    s_nop 1
    v_subrev_f32 v30, s47, v28
    v_mul_f32 v30, v19, v30
    v_exp_f32 v30, v30
    v_mov_b32 v28, s47
    v_mul_f32 v29, 0xbfb8aa3b, v28
    v_mul_f32 v18, v18, v30
    v_mul_f32 v24, v24, v30
    v_mul_f32 v25, v25, v30
    v_mul_f32 v26, v26, v30
    v_mul_f32 v27, v27, v30
    s_branch CONT_10
RESC_11:
    v_max_f32_dpp v30, v36, v36 row_ror:8 row_mask:0xf bank_mask:0xf
    s_nop 1
    v_max_f32_dpp v30, v30, v30 row_ror:4 row_mask:0xf bank_mask:0xf
    s_nop 1
    v_max_f32_dpp v30, v30, v30 row_bcast:15 row_mask:0xa bank_mask:0xf
    s_nop 1
    v_max_f32_dpp v30, v30, v30 row_bcast:31 row_mask:0xc bank_mask:0xf
    s_nop 0
    v_readlane_b32 s47, v30, 63
    s_nop 1
    v_subrev_f32 v30, s47, v28
    v_mul_f32 v30, v19, v30
    v_exp_f32 v30, v30
    v_mov_b32 v28, s47
    v_mul_f32 v29, 0xbfb8aa3b, v28
    v_mul_f32 v18, v18, v30
    v_mul_f32 v24, v24, v30
    v_mul_f32 v25, v25, v30
    v_mul_f32 v26, v26, v30
    v_mul_f32 v27, v27, v30
    s_branch CONT_12
RESC_13:
    v_max_f32_dpp v30, v36, v36 row_ror:8 row_mask:0xf bank_mask:0xf
    s_nop 1
    v_max_f32_dpp v30, v30, v30 row_ror:4 row_mask:0xf bank_mask:0xf
    s_nop 1
    v_max_f32_dpp v30, v30, v30 row_bcast:15 row_mask:0xa bank_mask:0xf
    s_nop 1
    v_max_f32_dpp v30, v30, v30 row_bcast:31 row_mask:0xc bank_mask:0xf
    s_nop 0
    v_readlane_b32 s47, v30, 63
    s_nop 1
    v_subrev_f32 v30, s47, v28
    v_mul_f32 v30, v19, v30
    v_exp_f32 v30, v30
    v_mov_b32 v28, s47
    v_mul_f32 v29, 0xbfb8aa3b, v28
    v_mul_f32 v18, v18, v30
    v_mul_f32 v24, v24, v30
    v_mul_f32 v25, v25, v30
    v_mul_f32 v26, v26, v30
    v_mul_f32 v27, v27, v30
    s_branch CONT_14
RESC_15:
    v_max_f32_dpp v30, v36, v36 row_ror:8 row_mask:0xf bank_mask:0xf
    s_nop 1
    v_max_f32_dpp v30, v30, v30 row_ror:4 row_mask:0xf bank_mask:0xf
    s_nop 1
    v_max_f32_dpp v30, v30, v30 row_bcast:15 row_mask:0xa bank_mask:0xf
    s_nop 1
    v_max_f32_dpp v30, v30, v30 row_bcast:31 row_mask:0xc bank_mask:0xf
    s_nop 0
    v_readlane_b32 s47, v30, 63
    s_nop 1
    v_subrev_f32 v30, s47, v28
    v_mul_f32 v30, v19, v30
    v_exp_f32 v30, v30
    v_mov_b32 v28, s47
    v_mul_f32 v29, 0xbfb8aa3b, v28
    v_mul_f32 v18, v18, v30
    v_mul_f32 v24, v24, v30
    v_mul_f32 v25, v25, v30
    v_mul_f32 v26, v26, v30
    v_mul_f32 v27, v27, v30
    s_branch CONT_16
RESC_17:
    v_max_f32_dpp v30, v36, v36 row_ror:8 row_mask:0xf bank_mask:0xf
    s_nop 1
    v_max_f32_dpp v30, v30, v30 row_ror:4 row_mask:0xf bank_mask:0xf
    s_nop 1
    v_max_f32_dpp v30, v30, v30 row_bcast:15 row_mask:0xa bank_mask:0xf
    s_nop 1
    v_max_f32_dpp v30, v30, v30 row_bcast:31 row_mask:0xc bank_mask:0xf
    s_nop 0
    v_readlane_b32 s47, v30, 63
    s_nop 1
    v_subrev_f32 v30, s47, v28
    v_mul_f32 v30, v19, v30
    v_exp_f32 v30, v30
    v_mov_b32 v28, s47
    v_mul_f32 v29, 0xbfb8aa3b, v28
    v_mul_f32 v18, v18, v30
    v_mul_f32 v24, v24, v30
    v_mul_f32 v25, v25, v30
    v_mul_f32 v26, v26, v30
    v_mul_f32 v27, v27, v30
    s_branch CONT_18
RESC_19:
    v_max_f32_dpp v30, v36, v36 row_ror:8 row_mask:0xf bank_mask:0xf
    s_nop 1
    v_max_f32_dpp v30, v30, v30 row_ror:4 row_mask:0xf bank_mask:0xf
    s_nop 1
    v_max_f32_dpp v30, v30, v30 row_bcast:15 row_mask:0xa bank_mask:0xf
    s_nop 1
    v_max_f32_dpp v30, v30, v30 row_bcast:31 row_mask:0xc bank_mask:0xf
    s_nop 0
    v_readlane_b32 s47, v30, 63
    s_nop 1
    v_subrev_f32 v30, s47, v28
    v_mul_f32 v30, v19, v30
    v_exp_f32 v30, v30
    v_mov_b32 v28, s47
    v_mul_f32 v29, 0xbfb8aa3b, v28
    v_mul_f32 v18, v18, v30
    v_mul_f32 v24, v24, v30
    v_mul_f32 v25, v25, v30
    v_mul_f32 v26, v26, v30
    v_mul_f32 v27, v27, v30
    s_branch CONT_20
RESC_21:
    v_max_f32_dpp v30, v36, v36 row_ror:8 row_mask:0xf bank_mask:0xf
    s_nop 1
    v_max_f32_dpp v30, v30, v30 row_ror:4 row_mask:0xf bank_mask:0xf
    s_nop 1
    v_max_f32_dpp v30, v30, v30 row_bcast:15 row_mask:0xa bank_mask:0xf
    s_nop 1
    v_max_f32_dpp v30, v30, v30 row_bcast:31 row_mask:0xc bank_mask:0xf
    s_nop 0
    v_readlane_b32 s47, v30, 63
    s_nop 1
    v_subrev_f32 v30, s47, v28
    v_mul_f32 v30, v19, v30
    v_exp_f32 v30, v30
    v_mov_b32 v28, s47
    v_mul_f32 v29, 0xbfb8aa3b, v28
    v_mul_f32 v18, v18, v30
    v_mul_f32 v24, v24, v30
    v_mul_f32 v25, v25, v30
    v_mul_f32 v26, v26, v30
    v_mul_f32 v27, v27, v30
    s_branch CONT_22
RESC_23:
    v_max_f32_dpp v30, v36, v36 row_ror:8 row_mask:0xf bank_mask:0xf
    s_nop 1
    v_max_f32_dpp v30, v30, v30 row_ror:4 row_mask:0xf bank_mask:0xf
    s_nop 1
    v_max_f32_dpp v30, v30, v30 row_bcast:15 row_mask:0xa bank_mask:0xf
    s_nop 1
    v_max_f32_dpp v30, v30, v30 row_bcast:31 row_mask:0xc bank_mask:0xf
    s_nop 0
    v_readlane_b32 s47, v30, 63
    s_nop 1
    v_subrev_f32 v30, s47, v28
    v_mul_f32 v30, v19, v30
    v_exp_f32 v30, v30
    v_mov_b32 v28, s47
    v_mul_f32 v29, 0xbfb8aa3b, v28
    v_mul_f32 v18, v18, v30
    v_mul_f32 v24, v24, v30
    v_mul_f32 v25, v25, v30
    v_mul_f32 v26, v26, v30
    v_mul_f32 v27, v27, v30
    s_branch CONT_24
RESC_25:
    v_max_f32_dpp v30, v36, v36 row_ror:8 row_mask:0xf bank_mask:0xf
    s_nop 1
    v_max_f32_dpp v30, v30, v30 row_ror:4 row_mask:0xf bank_mask:0xf
    s_nop 1
    v_max_f32_dpp v30, v30, v30 row_bcast:15 row_mask:0xa bank_mask:0xf
    s_nop 1
    v_max_f32_dpp v30, v30, v30 row_bcast:31 row_mask:0xc bank_mask:0xf
    s_nop 0
    v_readlane_b32 s47, v30, 63
    s_nop 1
    v_subrev_f32 v30, s47, v28
    v_mul_f32 v30, v19, v30
    v_exp_f32 v30, v30
    v_mov_b32 v28, s47
    v_mul_f32 v29, 0xbfb8aa3b, v28
    v_mul_f32 v18, v18, v30
    v_mul_f32 v24, v24, v30
    v_mul_f32 v25, v25, v30
    v_mul_f32 v26, v26, v30
    v_mul_f32 v27, v27, v30
    s_branch CONT_26
RESC_27:
    v_max_f32_dpp v30, v36, v36 row_ror:8 row_mask:0xf bank_mask:0xf
    s_nop 1
    v_max_f32_dpp v30, v30, v30 row_ror:4 row_mask:0xf bank_mask:0xf
    s_nop 1
    v_max_f32_dpp v30, v30, v30 row_bcast:15 row_mask:0xa bank_mask:0xf
    s_nop 1
    v_max_f32_dpp v30, v30, v30 row_bcast:31 row_mask:0xc bank_mask:0xf
    s_nop 0
    v_readlane_b32 s47, v30, 63
    s_nop 1
    v_subrev_f32 v30, s47, v28
    v_mul_f32 v30, v19, v30
    v_exp_f32 v30, v30
    v_mov_b32 v28, s47
    v_mul_f32 v29, 0xbfb8aa3b, v28
    v_mul_f32 v18, v18, v30
    v_mul_f32 v24, v24, v30
    v_mul_f32 v25, v25, v30
    v_mul_f32 v26, v26, v30
    v_mul_f32 v27, v27, v30
    s_branch CONT_28
RESC_29:
    v_max_f32_dpp v30, v36, v36 row_ror:8 row_mask:0xf bank_mask:0xf
    s_nop 1
    v_max_f32_dpp v30, v30, v30 row_ror:4 row_mask:0xf bank_mask:0xf
    s_nop 1
    v_max_f32_dpp v30, v30, v30 row_bcast:15 row_mask:0xa bank_mask:0xf
    s_nop 1
    v_max_f32_dpp v30, v30, v30 row_bcast:31 row_mask:0xc bank_mask:0xf
    s_nop 0
    v_readlane_b32 s47, v30, 63
    s_nop 1
    v_subrev_f32 v30, s47, v28
    v_mul_f32 v30, v19, v30
    v_exp_f32 v30, v30
    v_mov_b32 v28, s47
    v_mul_f32 v29, 0xbfb8aa3b, v28
    v_mul_f32 v18, v18, v30
    v_mul_f32 v24, v24, v30
    v_mul_f32 v25, v25, v30
    v_mul_f32 v26, v26, v30
    v_mul_f32 v27, v27, v30
    s_branch CONT_30
RESC_31:
    v_max_f32_dpp v30, v36, v36 row_ror:8 row_mask:0xf bank_mask:0xf
    s_nop 1
    v_max_f32_dpp v30, v30, v30 row_ror:4 row_mask:0xf bank_mask:0xf
    s_nop 1
    v_max_f32_dpp v30, v30, v30 row_bcast:15 row_mask:0xa bank_mask:0xf
    s_nop 1
    v_max_f32_dpp v30, v30, v30 row_bcast:31 row_mask:0xc bank_mask:0xf
    s_nop 0
    v_readlane_b32 s47, v30, 63
    s_nop 1
    v_subrev_f32 v30, s47, v28
    v_mul_f32 v30, v19, v30
    v_exp_f32 v30, v30
    v_mov_b32 v28, s47
    v_mul_f32 v29, 0xbfb8aa3b, v28
    v_mul_f32 v18, v18, v30
    v_mul_f32 v24, v24, v30
    v_mul_f32 v25, v25, v30
    v_mul_f32 v26, v26, v30
    v_mul_f32 v27, v27, v30
    s_branch CONT_32
AUX:
    s_setprio 3
    s_mov_b32 s64, s36
    s_mov_b32 s65, s37
    s_mov_b32 s66, 3145728
    s_mov_b32 s67, 0x00020000
    s_mov_b32 s68, s34
    s_mov_b32 s69, s35
    s_mov_b32 s70, 4096
    s_mov_b32 s71, 0x00020000
    s_mov_b32 s72, s16
    s_mov_b32 s73, s17
    s_mov_b32 s74, 4096
    s_mov_b32 s75, 0x00020000
    v_and_b32 v1, 63, v0
    v_and_b32 v2, 15, v0
    v_bfe_u32 v3, v0, 4, 2
    s_lshl_b32 s83, s44, 10
    s_lshl_b32 s80, s86, 8
    s_cmp_ge_u32 s2, 48
    s_cbranch_scc1 AUX_NP0
    s_load_dwordx2 s[90:91], s[42:43], s80
    v_lshlrev_b32 v12, 4, v2
    v_lshl_add_u32 v12, v3, 10, v12
    buffer_load_dwordx4 v[20:23], v12, s[68:71], s80 offen
    v_lshrrev_b32 v12, 3, v2
    v_lshl_add_u32 v13, v3, 1, 1
    v_sub_u32 v13, v13, v12
    v_mul_u32_u24 v13, 6144, v13
    v_and_b32 v12, 7, v2
    v_lshl_add_u32 v17, v12, 4, v13
    s_mul_i32 s79, s86, 786432
    s_lshl_b32 s81, s2, 7
    s_add_u32 s79, s79, s81
    buffer_load_dwordx4 v[64:67], v17, s[64:67], s79 offen
    s_add_u32 s79, s79, 49152
    buffer_load_dwordx4 v[68:71], v17, s[64:67], s79 offen
    s_add_u32 s79, s79, 49152
    buffer_load_dwordx4 v[72:75], v17, s[64:67], s79 offen
    s_add_u32 s79, s79, 49152
    buffer_load_dwordx4 v[76:79], v17, s[64:67], s79 offen
    s_add_u32 s79, s79, 49152
    buffer_load_dwordx4 v[80:83], v17, s[64:67], s79 offen
    s_add_u32 s79, s79, 49152
    buffer_load_dwordx4 v[84:87], v17, s[64:67], s79 offen
    s_add_u32 s79, s79, 49152
    buffer_load_dwordx4 v[88:91], v17, s[64:67], s79 offen
    s_add_u32 s79, s79, 49152
    buffer_load_dwordx4 v[92:95], v17, s[64:67], s79 offen
    s_add_u32 s79, s79, 49152
    buffer_load_dwordx4 v[96:99], v17, s[64:67], s79 offen
    s_add_u32 s79, s79, 49152
    buffer_load_dwordx4 v[100:103], v17, s[64:67], s79 offen
    s_add_u32 s79, s79, 49152
    buffer_load_dwordx4 v[104:107], v17, s[64:67], s79 offen
    s_add_u32 s79, s79, 49152
    buffer_load_dwordx4 v[108:111], v17, s[64:67], s79 offen
    s_add_u32 s79, s79, 49152
    buffer_load_dwordx4 v[112:115], v17, s[64:67], s79 offen
    s_add_u32 s79, s79, 49152
    buffer_load_dwordx4 v[116:119], v17, s[64:67], s79 offen
    s_add_u32 s79, s79, 49152
    buffer_load_dwordx4 v[120:123], v17, s[64:67], s79 offen
    s_add_u32 s79, s79, 49152
    buffer_load_dwordx4 v[124:127], v17, s[64:67], s79 offen
AUX_NP0:
    v_lshlrev_b32 v12, 4, v1
    buffer_load_dwordx4 v[60:63], v12, s[72:75], s83 offen
    v_and_b32 v13, 31, v1
    v_lshlrev_b32 v13, 3, v13
    v_lshrrev_b32 v14, 5, v1
    v_lshl_add_u32 v13, v14, 2, v13
    s_add_u32 s80, s80, s83
    buffer_load_dword v19, v13, s[72:75], s80 offen
    s_mov_b32 s52, s22
    s_mov_b32 s53, s23
    s_mov_b32 s54, 4194304
    s_mov_b32 s55, 0x00020000
    v_lshlrev_b32 v18, 4, v2
    v_lshl_add_u32 v18, v3, 13, v18
    s_lshl_b32 s80, s86, 20
    s_lshr_b32 s81, s45, 1
    s_lshl_b32 s81, s81, 8
    s_add_u32 s80, s80, s81
    s_mov_b32 s92, s80
    buffer_load_dwordx4 v[128:131], v18, s[52:55], s92 offen nt
    s_add_u32 s92, s92, 32768
    buffer_load_dwordx4 v[132:135], v18, s[52:55], s92 offen nt
    s_add_u32 s92, s92, 32768
    buffer_load_dwordx4 v[136:139], v18, s[52:55], s92 offen nt
    s_add_u32 s92, s92, 32768
    buffer_load_dwordx4 v[140:143], v18, s[52:55], s92 offen nt
    s_add_u32 s92, s92, 32768
    buffer_load_dwordx4 v[144:147], v18, s[52:55], s92 offen nt
    s_add_u32 s92, s92, 32768
    buffer_load_dwordx4 v[148:151], v18, s[52:55], s92 offen nt
    s_add_u32 s92, s92, 32768
    buffer_load_dwordx4 v[152:155], v18, s[52:55], s92 offen nt
    s_add_u32 s92, s92, 32768
    buffer_load_dwordx4 v[156:159], v18, s[52:55], s92 offen nt
    s_add_u32 s92, s92, 32768
    buffer_load_dwordx4 v[160:163], v18, s[52:55], s92 offen nt
    s_add_u32 s92, s92, 32768
    buffer_load_dwordx4 v[164:167], v18, s[52:55], s92 offen nt
    s_add_u32 s92, s92, 32768
    buffer_load_dwordx4 v[168:171], v18, s[52:55], s92 offen nt
    s_add_u32 s92, s92, 32768
    buffer_load_dwordx4 v[172:175], v18, s[52:55], s92 offen nt
    s_add_u32 s92, s92, 32768
    buffer_load_dwordx4 v[176:179], v18, s[52:55], s92 offen nt
    s_add_u32 s92, s92, 32768
    buffer_load_dwordx4 v[180:183], v18, s[52:55], s92 offen nt
    s_add_u32 s92, s92, 32768
    buffer_load_dwordx4 v[184:187], v18, s[52:55], s92 offen nt
    s_add_u32 s92, s92, 32768
    buffer_load_dwordx4 v[188:191], v18, s[52:55], s92 offen nt
    s_add_u32 s92, s92, 32768
    buffer_load_dwordx4 v[192:195], v18, s[52:55], s92 offen nt
    s_add_u32 s92, s92, 32768
    buffer_load_dwordx4 v[196:199], v18, s[52:55], s92 offen nt
    s_add_u32 s92, s92, 32768
    buffer_load_dwordx4 v[200:203], v18, s[52:55], s92 offen nt
    s_add_u32 s92, s92, 32768
    buffer_load_dwordx4 v[204:207], v18, s[52:55], s92 offen nt
    s_add_u32 s92, s92, 32768
    buffer_load_dwordx4 v[208:211], v18, s[52:55], s92 offen nt
    s_add_u32 s92, s92, 32768
    buffer_load_dwordx4 v[212:215], v18, s[52:55], s92 offen nt
    s_add_u32 s92, s92, 32768
    buffer_load_dwordx4 v[216:219], v18, s[52:55], s92 offen nt
    s_add_u32 s92, s92, 32768
    buffer_load_dwordx4 v[220:223], v18, s[52:55], s92 offen nt
    s_add_u32 s92, s92, 32768
    buffer_load_dwordx4 v[224:227], v18, s[52:55], s92 offen nt
    s_add_u32 s92, s92, 32768
    buffer_load_dwordx4 v[228:231], v18, s[52:55], s92 offen nt
    s_add_u32 s92, s92, 32768
    buffer_load_dwordx4 v[232:235], v18, s[52:55], s92 offen nt
    s_add_u32 s92, s92, 32768
    buffer_load_dwordx4 v[236:239], v18, s[52:55], s92 offen nt
    s_add_u32 s92, s92, 32768
    buffer_load_dwordx4 v[240:243], v18, s[52:55], s92 offen nt
    s_add_u32 s92, s92, 32768
    buffer_load_dwordx4 v[244:247], v18, s[52:55], s92 offen nt
    s_add_u32 s92, s92, 32768
    buffer_load_dwordx4 v[248:251], v18, s[52:55], s92 offen nt
    s_add_u32 s92, s92, 32768
    buffer_load_dwordx4 v[252:255], v18, s[52:55], s92 offen nt
    s_add_u32 s92, s92, 32768
    v_and_b32 v1, 63, v0
    v_and_b32 v2, 15, v0
    v_bfe_u32 v3, v0, 4, 2
    v_and_b32 v12, 1, v2
    v_lshlrev_b32 v12, 4, v12
    v_mov_b32 v13, 0xffff
    v_lshlrev_b32 v13, v12, v13
    v_mov_b32 v14, 0x0100
    v_mov_b32 v15, 0x0302
    v_cmp_gt_u32 vcc, 8, v2
    v_cndmask_b32 v14, v14, v15, vcc
    v_lshlrev_b32 v14, v12, v14
    v_mov_b32 v15, 0x0c0c0c0c
    v_bfi_b32 v14, v13, v14, v15
    v_bfe_u32 v12, v2, 1, 2
    v_cmp_eq_u32 vcc, 0, v12
    v_cndmask_b32 v4, v15, v14, vcc
    v_cndmask_b32 v8, 0, v13, vcc
    v_cmp_eq_u32 vcc, 1, v12
    v_cndmask_b32 v5, v15, v14, vcc
    v_cndmask_b32 v9, 0, v13, vcc
    v_cmp_eq_u32 vcc, 2, v12
    v_cndmask_b32 v6, v15, v14, vcc
    v_cndmask_b32 v10, 0, v13, vcc
    v_cmp_eq_u32 vcc, 3, v12
    v_cndmask_b32 v7, v15, v14, vcc
    v_cndmask_b32 v11, 0, v13, vcc
    s_waitcnt lgkmcnt(0)
    s_mul_i32 s48, s48, 1664525
    s_add_u32 s48, s48, 1013904223
    s_mul_i32 s49, s49, 22695477
    s_add_u32 s49, s49, 1
    v_bfe_u32 v12, v2, 1, 2
    v_lshl_add_u32 v12, v3, 2, v12
    s_lshl_b32 s47, s86, 4
    s_lshl_b32 s50, s44, 6
    s_add_u32 s47, s47, s50
    v_add_u32 v12, s47, v12
    v_lshlrev_b32 v12, 12, v12
    v_and_b32 v13, 1, v2
    v_lshlrev_b32 v13, 5, v13
    v_lshrrev_b32 v14, 3, v2
    v_lshl_add_u32 v13, v14, 4, v13
    s_lshl_b32 s47, s45, 6
    v_add3_u32 v16, v12, v13, s47
    v_mov_b32 v26, s48
    v_mov_b32 v27, s49
    v_mov_b32 v29, 0x07060302
    s_cmp_ge_u32 s2, 48
    s_cbranch_scc1 AUX_W2
    s_mul_i32 s90, s90, 1664525
    s_add_u32 s90, s90, 1013904223
    s_mul_i32 s91, s91, 22695477
    s_add_u32 s91, s91, 1
    s_lshl_b32 s47, s86, 10
    v_lshlrev_b32 v30, 4, v2
    v_lshl_add_u32 v30, v3, 2, v30
    v_add_u32 v30, s47, v30
    v_lshlrev_b32 v31, 8, v3
    v_add_u32 v31, s47, v31
    s_waitcnt vmcnt(50)
    v_lshlrev_b32 v32, 16, v20
    v_and_b32 v33, 0xffff0000, v20
    v_lshlrev_b32 v34, 16, v21
    v_and_b32 v35, 0xffff0000, v21
    v_lshlrev_b32 v36, 16, v22
    v_and_b32 v37, 0xffff0000, v22
    v_lshlrev_b32 v38, 16, v23
    v_and_b32 v39, 0xffff0000, v23
    v_mul_f32 v40, 0xbfb8aa3b, v32
    v_mul_f32 v41, 0xbfb8aa3b, v33
    v_mul_f32 v42, 0xbfb8aa3b, v34
    v_mul_f32 v43, 0xbfb8aa3b, v35
    v_mul_f32 v44, 0xbfb8aa3b, v36
    v_mul_f32 v45, 0xbfb8aa3b, v37
    v_mul_f32 v46, 0xbfb8aa3b, v38
    v_mul_f32 v47, 0xbfb8aa3b, v39
    v_exp_f32 v40, v40
    v_exp_f32 v41, v41
    v_exp_f32 v42, v42
    v_exp_f32 v43, v43
    v_exp_f32 v44, v44
    v_exp_f32 v45, v45
    v_exp_f32 v46, v46
    v_exp_f32 v47, v47
    v_add_f32 v40, 1.0, v40
    v_add_f32 v41, 1.0, v41
    v_add_f32 v42, 1.0, v42
    v_add_f32 v43, 1.0, v43
    v_add_f32 v44, 1.0, v44
    v_add_f32 v45, 1.0, v45
    v_add_f32 v46, 1.0, v46
    v_add_f32 v47, 1.0, v47
    v_rcp_f32 v40, v40
    v_rcp_f32 v41, v41
    v_rcp_f32 v42, v42
    v_rcp_f32 v43, v43
    v_rcp_f32 v44, v44
    v_rcp_f32 v45, v45
    v_rcp_f32 v46, v46
    v_rcp_f32 v47, v47
    v_mul_f32 v32, v32, v40
    v_mul_f32 v33, v33, v41
    v_mul_f32 v34, v34, v42
    v_mul_f32 v35, v35, v43
    v_mul_f32 v36, v36, v44
    v_mul_f32 v37, v37, v45
    v_mul_f32 v38, v38, v46
    v_mul_f32 v39, v39, v47
    v_cvt_pk_bf16_f32 v40, v32, v33
    v_cvt_pk_bf16_f32 v41, v34, v35
    v_cvt_pk_bf16_f32 v42, v36, v37
    v_cvt_pk_bf16_f32 v43, v38, v39
    ds_write_b32 v30, v40 offset:20736
    ds_write_b32 v30, v41 offset:20992
    ds_write_b32 v30, v42 offset:21248
    ds_write_b32 v30, v43 offset:21504
    s_waitcnt lgkmcnt(0)
    ds_read_b128 v[20:23], v31 offset:20736
    ds_read_b128 v[56:59], v31 offset:20752
    s_lshl_b32 s50, s86, 12
    v_lshlrev_b32 v30, 4, v1
    v_add_u32 v30, s50, v30
    v_lshrrev_b32 v28, 5, v1
    v_lshlrev_b32 v28, 4, v28
    v_and_b32 v24, 7, v1
    v_add_u32 v28, v28, v24
    v_lshlrev_b32 v28, 4, v28
    v_bfe_u32 v24, v1, 3, 2
    v_lshl_add_u32 v28, v24, 2, v28
    v_add_u32 v28, s47, v28
    s_waitcnt lgkmcnt(1)
    v_perm_b32 v48, v20, v20, v4
    v_perm_b32 v49, v20, v20, v5
    v_perm_b32 v50, v20, v20, v6
    v_perm_b32 v51, v20, v20, v7
    v_perm_b32 v52, v21, v21, v4
    v_perm_b32 v53, v21, v21, v5
    v_perm_b32 v54, v21, v21, v6
    v_perm_b32 v55, v21, v21, v7
    s_waitcnt vmcnt(49)
    ds_read_b128 v[12:15], v31 offset:20768
    v_mfma_f32_16x16x32_bf16 v[32:35], v[64:67], v[48:51], 0
    v_perm_b32 v48, v22, v22, v4
    v_perm_b32 v49, v22, v22, v5
    v_perm_b32 v50, v22, v22, v6
    v_perm_b32 v51, v22, v22, v7
    v_mfma_f32_16x16x32_bf16 v[36:39], v[64:67], v[52:55], 0
    v_perm_b32 v52, v23, v23, v4
    v_perm_b32 v53, v23, v23, v5
    v_perm_b32 v54, v23, v23, v6
    v_perm_b32 v55, v23, v23, v7
    v_mfma_f32_16x16x32_bf16 v[40:43], v[64:67], v[48:51], 0
    s_waitcnt lgkmcnt(1)
    v_perm_b32 v48, v56, v56, v4
    v_perm_b32 v49, v56, v56, v5
    v_perm_b32 v50, v56, v56, v6
    v_perm_b32 v51, v56, v56, v7
    v_mfma_f32_16x16x32_bf16 v[44:47], v[64:67], v[52:55], 0
    v_perm_b32 v52, v57, v57, v4
    v_perm_b32 v53, v57, v57, v5
    v_perm_b32 v54, v57, v57, v6
    v_perm_b32 v55, v57, v57, v7
    s_waitcnt vmcnt(48)
    ds_read_b128 v[20:23], v31 offset:20784
    v_mfma_f32_16x16x32_bf16 v[32:35], v[68:71], v[48:51], v[32:35]
    v_perm_b32 v48, v58, v58, v4
    v_perm_b32 v49, v58, v58, v5
    v_perm_b32 v50, v58, v58, v6
    v_perm_b32 v51, v58, v58, v7
    v_mfma_f32_16x16x32_bf16 v[36:39], v[68:71], v[52:55], v[36:39]
    v_perm_b32 v52, v59, v59, v4
    v_perm_b32 v53, v59, v59, v5
    v_perm_b32 v54, v59, v59, v6
    v_perm_b32 v55, v59, v59, v7
    v_mfma_f32_16x16x32_bf16 v[40:43], v[68:71], v[48:51], v[40:43]
    s_waitcnt lgkmcnt(1)
    v_perm_b32 v48, v12, v12, v4
    v_perm_b32 v49, v12, v12, v5
    v_perm_b32 v50, v12, v12, v6
    v_perm_b32 v51, v12, v12, v7
    v_mfma_f32_16x16x32_bf16 v[44:47], v[68:71], v[52:55], v[44:47]
    v_perm_b32 v52, v13, v13, v4
    v_perm_b32 v53, v13, v13, v5
    v_perm_b32 v54, v13, v13, v6
    v_perm_b32 v55, v13, v13, v7
    s_waitcnt vmcnt(47)
    ds_read_b128 v[56:59], v31 offset:20800
    v_mfma_f32_16x16x32_bf16 v[32:35], v[72:75], v[48:51], v[32:35]
    v_perm_b32 v48, v14, v14, v4
    v_perm_b32 v49, v14, v14, v5
    v_perm_b32 v50, v14, v14, v6
    v_perm_b32 v51, v14, v14, v7
    v_mfma_f32_16x16x32_bf16 v[36:39], v[72:75], v[52:55], v[36:39]
    v_perm_b32 v52, v15, v15, v4
    v_perm_b32 v53, v15, v15, v5
    v_perm_b32 v54, v15, v15, v6
    v_perm_b32 v55, v15, v15, v7
    v_mfma_f32_16x16x32_bf16 v[40:43], v[72:75], v[48:51], v[40:43]
    s_waitcnt lgkmcnt(1)
    v_perm_b32 v48, v20, v20, v4
    v_perm_b32 v49, v20, v20, v5
    v_perm_b32 v50, v20, v20, v6
    v_perm_b32 v51, v20, v20, v7
    v_mfma_f32_16x16x32_bf16 v[44:47], v[72:75], v[52:55], v[44:47]
    v_perm_b32 v52, v21, v21, v4
    v_perm_b32 v53, v21, v21, v5
    v_perm_b32 v54, v21, v21, v6
    v_perm_b32 v55, v21, v21, v7
    s_waitcnt vmcnt(46)
    ds_read_b128 v[12:15], v31 offset:20816
    v_mfma_f32_16x16x32_bf16 v[32:35], v[76:79], v[48:51], v[32:35]
    v_perm_b32 v48, v22, v22, v4
    v_perm_b32 v49, v22, v22, v5
    v_perm_b32 v50, v22, v22, v6
    v_perm_b32 v51, v22, v22, v7
    v_mfma_f32_16x16x32_bf16 v[36:39], v[76:79], v[52:55], v[36:39]
    v_perm_b32 v52, v23, v23, v4
    v_perm_b32 v53, v23, v23, v5
    v_perm_b32 v54, v23, v23, v6
    v_perm_b32 v55, v23, v23, v7
    v_mfma_f32_16x16x32_bf16 v[40:43], v[76:79], v[48:51], v[40:43]
    s_waitcnt lgkmcnt(1)
    v_perm_b32 v48, v56, v56, v4
    v_perm_b32 v49, v56, v56, v5
    v_perm_b32 v50, v56, v56, v6
    v_perm_b32 v51, v56, v56, v7
    v_mfma_f32_16x16x32_bf16 v[44:47], v[76:79], v[52:55], v[44:47]
    v_perm_b32 v52, v57, v57, v4
    v_perm_b32 v53, v57, v57, v5
    v_perm_b32 v54, v57, v57, v6
    v_perm_b32 v55, v57, v57, v7
    s_waitcnt vmcnt(45)
    ds_read_b128 v[20:23], v31 offset:20832
    v_mfma_f32_16x16x32_bf16 v[32:35], v[80:83], v[48:51], v[32:35]
    v_perm_b32 v48, v58, v58, v4
    v_perm_b32 v49, v58, v58, v5
    v_perm_b32 v50, v58, v58, v6
    v_perm_b32 v51, v58, v58, v7
    v_mfma_f32_16x16x32_bf16 v[36:39], v[80:83], v[52:55], v[36:39]
    v_perm_b32 v52, v59, v59, v4
    v_perm_b32 v53, v59, v59, v5
    v_perm_b32 v54, v59, v59, v6
    v_perm_b32 v55, v59, v59, v7
    v_mfma_f32_16x16x32_bf16 v[40:43], v[80:83], v[48:51], v[40:43]
    s_waitcnt lgkmcnt(1)
    v_perm_b32 v48, v12, v12, v4
    v_perm_b32 v49, v12, v12, v5
    v_perm_b32 v50, v12, v12, v6
    v_perm_b32 v51, v12, v12, v7
    v_mfma_f32_16x16x32_bf16 v[44:47], v[80:83], v[52:55], v[44:47]
    v_perm_b32 v52, v13, v13, v4
    v_perm_b32 v53, v13, v13, v5
    v_perm_b32 v54, v13, v13, v6
    v_perm_b32 v55, v13, v13, v7
    s_waitcnt vmcnt(44)
    ds_read_b128 v[56:59], v31 offset:20848
    v_mfma_f32_16x16x32_bf16 v[32:35], v[84:87], v[48:51], v[32:35]
    v_perm_b32 v48, v14, v14, v4
    v_perm_b32 v49, v14, v14, v5
    v_perm_b32 v50, v14, v14, v6
    v_perm_b32 v51, v14, v14, v7
    v_mfma_f32_16x16x32_bf16 v[36:39], v[84:87], v[52:55], v[36:39]
    v_perm_b32 v52, v15, v15, v4
    v_perm_b32 v53, v15, v15, v5
    v_perm_b32 v54, v15, v15, v6
    v_perm_b32 v55, v15, v15, v7
    v_mfma_f32_16x16x32_bf16 v[40:43], v[84:87], v[48:51], v[40:43]
    s_waitcnt lgkmcnt(1)
    v_perm_b32 v48, v20, v20, v4
    v_perm_b32 v49, v20, v20, v5
    v_perm_b32 v50, v20, v20, v6
    v_perm_b32 v51, v20, v20, v7
    v_mfma_f32_16x16x32_bf16 v[44:47], v[84:87], v[52:55], v[44:47]
    v_perm_b32 v52, v21, v21, v4
    v_perm_b32 v53, v21, v21, v5
    v_perm_b32 v54, v21, v21, v6
    v_perm_b32 v55, v21, v21, v7
    s_waitcnt vmcnt(43)
    ds_read_b128 v[12:15], v31 offset:20864
    v_mfma_f32_16x16x32_bf16 v[32:35], v[88:91], v[48:51], v[32:35]
    v_perm_b32 v48, v22, v22, v4
    v_perm_b32 v49, v22, v22, v5
    v_perm_b32 v50, v22, v22, v6
    v_perm_b32 v51, v22, v22, v7
    v_mfma_f32_16x16x32_bf16 v[36:39], v[88:91], v[52:55], v[36:39]
    v_perm_b32 v52, v23, v23, v4
    v_perm_b32 v53, v23, v23, v5
    v_perm_b32 v54, v23, v23, v6
    v_perm_b32 v55, v23, v23, v7
    v_mfma_f32_16x16x32_bf16 v[40:43], v[88:91], v[48:51], v[40:43]
    s_waitcnt lgkmcnt(1)
    v_perm_b32 v48, v56, v56, v4
    v_perm_b32 v49, v56, v56, v5
    v_perm_b32 v50, v56, v56, v6
    v_perm_b32 v51, v56, v56, v7
    v_mfma_f32_16x16x32_bf16 v[44:47], v[88:91], v[52:55], v[44:47]
    v_perm_b32 v52, v57, v57, v4
    v_perm_b32 v53, v57, v57, v5
    v_perm_b32 v54, v57, v57, v6
    v_perm_b32 v55, v57, v57, v7
    s_waitcnt vmcnt(42)
    ds_read_b128 v[20:23], v31 offset:20880
    v_mfma_f32_16x16x32_bf16 v[32:35], v[92:95], v[48:51], v[32:35]
    v_perm_b32 v48, v58, v58, v4
    v_perm_b32 v49, v58, v58, v5
    v_perm_b32 v50, v58, v58, v6
    v_perm_b32 v51, v58, v58, v7
    v_mfma_f32_16x16x32_bf16 v[36:39], v[92:95], v[52:55], v[36:39]
    v_perm_b32 v52, v59, v59, v4
    v_perm_b32 v53, v59, v59, v5
    v_perm_b32 v54, v59, v59, v6
    v_perm_b32 v55, v59, v59, v7
    v_mfma_f32_16x16x32_bf16 v[40:43], v[92:95], v[48:51], v[40:43]
    s_waitcnt lgkmcnt(1)
    v_perm_b32 v48, v12, v12, v4
    v_perm_b32 v49, v12, v12, v5
    v_perm_b32 v50, v12, v12, v6
    v_perm_b32 v51, v12, v12, v7
    v_mfma_f32_16x16x32_bf16 v[44:47], v[92:95], v[52:55], v[44:47]
    v_perm_b32 v52, v13, v13, v4
    v_perm_b32 v53, v13, v13, v5
    v_perm_b32 v54, v13, v13, v6
    v_perm_b32 v55, v13, v13, v7
    s_waitcnt vmcnt(41)
    ds_read_b128 v[56:59], v31 offset:20896
    v_mfma_f32_16x16x32_bf16 v[32:35], v[96:99], v[48:51], v[32:35]
    v_perm_b32 v48, v14, v14, v4
    v_perm_b32 v49, v14, v14, v5
    v_perm_b32 v50, v14, v14, v6
    v_perm_b32 v51, v14, v14, v7
    v_mfma_f32_16x16x32_bf16 v[36:39], v[96:99], v[52:55], v[36:39]
    v_perm_b32 v52, v15, v15, v4
    v_perm_b32 v53, v15, v15, v5
    v_perm_b32 v54, v15, v15, v6
    v_perm_b32 v55, v15, v15, v7
    v_mfma_f32_16x16x32_bf16 v[40:43], v[96:99], v[48:51], v[40:43]
    s_waitcnt lgkmcnt(1)
    v_perm_b32 v48, v20, v20, v4
    v_perm_b32 v49, v20, v20, v5
    v_perm_b32 v50, v20, v20, v6
    v_perm_b32 v51, v20, v20, v7
    v_mfma_f32_16x16x32_bf16 v[44:47], v[96:99], v[52:55], v[44:47]
    v_perm_b32 v52, v21, v21, v4
    v_perm_b32 v53, v21, v21, v5
    v_perm_b32 v54, v21, v21, v6
    v_perm_b32 v55, v21, v21, v7
    s_waitcnt vmcnt(40)
    ds_read_b128 v[12:15], v31 offset:20912
    v_mfma_f32_16x16x32_bf16 v[32:35], v[100:103], v[48:51], v[32:35]
    v_perm_b32 v48, v22, v22, v4
    v_perm_b32 v49, v22, v22, v5
    v_perm_b32 v50, v22, v22, v6
    v_perm_b32 v51, v22, v22, v7
    v_mfma_f32_16x16x32_bf16 v[36:39], v[100:103], v[52:55], v[36:39]
    v_perm_b32 v52, v23, v23, v4
    v_perm_b32 v53, v23, v23, v5
    v_perm_b32 v54, v23, v23, v6
    v_perm_b32 v55, v23, v23, v7
    v_mfma_f32_16x16x32_bf16 v[40:43], v[100:103], v[48:51], v[40:43]
    s_waitcnt lgkmcnt(1)
    v_perm_b32 v48, v56, v56, v4
    v_perm_b32 v49, v56, v56, v5
    v_perm_b32 v50, v56, v56, v6
    v_perm_b32 v51, v56, v56, v7
    v_mfma_f32_16x16x32_bf16 v[44:47], v[100:103], v[52:55], v[44:47]
    v_perm_b32 v52, v57, v57, v4
    v_perm_b32 v53, v57, v57, v5
    v_perm_b32 v54, v57, v57, v6
    v_perm_b32 v55, v57, v57, v7
    s_waitcnt vmcnt(39)
    ds_read_b128 v[20:23], v31 offset:20928
    v_mfma_f32_16x16x32_bf16 v[32:35], v[104:107], v[48:51], v[32:35]
    v_perm_b32 v48, v58, v58, v4
    v_perm_b32 v49, v58, v58, v5
    v_perm_b32 v50, v58, v58, v6
    v_perm_b32 v51, v58, v58, v7
    v_mfma_f32_16x16x32_bf16 v[36:39], v[104:107], v[52:55], v[36:39]
    v_perm_b32 v52, v59, v59, v4
    v_perm_b32 v53, v59, v59, v5
    v_perm_b32 v54, v59, v59, v6
    v_perm_b32 v55, v59, v59, v7
    v_mfma_f32_16x16x32_bf16 v[40:43], v[104:107], v[48:51], v[40:43]
    s_waitcnt lgkmcnt(1)
    v_perm_b32 v48, v12, v12, v4
    v_perm_b32 v49, v12, v12, v5
    v_perm_b32 v50, v12, v12, v6
    v_perm_b32 v51, v12, v12, v7
    v_mfma_f32_16x16x32_bf16 v[44:47], v[104:107], v[52:55], v[44:47]
    v_perm_b32 v52, v13, v13, v4
    v_perm_b32 v53, v13, v13, v5
    v_perm_b32 v54, v13, v13, v6
    v_perm_b32 v55, v13, v13, v7
    s_waitcnt vmcnt(38)
    ds_read_b128 v[56:59], v31 offset:20944
    v_mfma_f32_16x16x32_bf16 v[32:35], v[108:111], v[48:51], v[32:35]
    v_perm_b32 v48, v14, v14, v4
    v_perm_b32 v49, v14, v14, v5
    v_perm_b32 v50, v14, v14, v6
    v_perm_b32 v51, v14, v14, v7
    v_mfma_f32_16x16x32_bf16 v[36:39], v[108:111], v[52:55], v[36:39]
    v_perm_b32 v52, v15, v15, v4
    v_perm_b32 v53, v15, v15, v5
    v_perm_b32 v54, v15, v15, v6
    v_perm_b32 v55, v15, v15, v7
    v_mfma_f32_16x16x32_bf16 v[40:43], v[108:111], v[48:51], v[40:43]
    s_waitcnt lgkmcnt(1)
    v_perm_b32 v48, v20, v20, v4
    v_perm_b32 v49, v20, v20, v5
    v_perm_b32 v50, v20, v20, v6
    v_perm_b32 v51, v20, v20, v7
    v_mfma_f32_16x16x32_bf16 v[44:47], v[108:111], v[52:55], v[44:47]
    v_perm_b32 v52, v21, v21, v4
    v_perm_b32 v53, v21, v21, v5
    v_perm_b32 v54, v21, v21, v6
    v_perm_b32 v55, v21, v21, v7
    s_waitcnt vmcnt(37)
    ds_read_b128 v[12:15], v31 offset:20960
    v_mfma_f32_16x16x32_bf16 v[32:35], v[112:115], v[48:51], v[32:35]
    v_perm_b32 v48, v22, v22, v4
    v_perm_b32 v49, v22, v22, v5
    v_perm_b32 v50, v22, v22, v6
    v_perm_b32 v51, v22, v22, v7
    v_mfma_f32_16x16x32_bf16 v[36:39], v[112:115], v[52:55], v[36:39]
    v_perm_b32 v52, v23, v23, v4
    v_perm_b32 v53, v23, v23, v5
    v_perm_b32 v54, v23, v23, v6
    v_perm_b32 v55, v23, v23, v7
    v_mfma_f32_16x16x32_bf16 v[40:43], v[112:115], v[48:51], v[40:43]
    s_waitcnt lgkmcnt(1)
    v_perm_b32 v48, v56, v56, v4
    v_perm_b32 v49, v56, v56, v5
    v_perm_b32 v50, v56, v56, v6
    v_perm_b32 v51, v56, v56, v7
    v_mfma_f32_16x16x32_bf16 v[44:47], v[112:115], v[52:55], v[44:47]
    v_perm_b32 v52, v57, v57, v4
    v_perm_b32 v53, v57, v57, v5
    v_perm_b32 v54, v57, v57, v6
    v_perm_b32 v55, v57, v57, v7
    s_waitcnt vmcnt(36)
    ds_read_b128 v[20:23], v31 offset:20976
    v_mfma_f32_16x16x32_bf16 v[32:35], v[116:119], v[48:51], v[32:35]
    v_perm_b32 v48, v58, v58, v4
    v_perm_b32 v49, v58, v58, v5
    v_perm_b32 v50, v58, v58, v6
    v_perm_b32 v51, v58, v58, v7
    v_mfma_f32_16x16x32_bf16 v[36:39], v[116:119], v[52:55], v[36:39]
    v_perm_b32 v52, v59, v59, v4
    v_perm_b32 v53, v59, v59, v5
    v_perm_b32 v54, v59, v59, v6
    v_perm_b32 v55, v59, v59, v7
    v_mfma_f32_16x16x32_bf16 v[40:43], v[116:119], v[48:51], v[40:43]
    s_waitcnt lgkmcnt(1)
    v_perm_b32 v48, v12, v12, v4
    v_perm_b32 v49, v12, v12, v5
    v_perm_b32 v50, v12, v12, v6
    v_perm_b32 v51, v12, v12, v7
    v_mfma_f32_16x16x32_bf16 v[44:47], v[116:119], v[52:55], v[44:47]
    v_perm_b32 v52, v13, v13, v4
    v_perm_b32 v53, v13, v13, v5
    v_perm_b32 v54, v13, v13, v6
    v_perm_b32 v55, v13, v13, v7
    s_waitcnt vmcnt(35)
    v_mfma_f32_16x16x32_bf16 v[32:35], v[120:123], v[48:51], v[32:35]
    v_perm_b32 v48, v14, v14, v4
    v_perm_b32 v49, v14, v14, v5
    v_perm_b32 v50, v14, v14, v6
    v_perm_b32 v51, v14, v14, v7
    v_mfma_f32_16x16x32_bf16 v[36:39], v[120:123], v[52:55], v[36:39]
    v_perm_b32 v52, v15, v15, v4
    v_perm_b32 v53, v15, v15, v5
    v_perm_b32 v54, v15, v15, v6
    v_perm_b32 v55, v15, v15, v7
    v_mfma_f32_16x16x32_bf16 v[40:43], v[120:123], v[48:51], v[40:43]
    s_waitcnt lgkmcnt(0)
    v_perm_b32 v48, v20, v20, v4
    v_perm_b32 v49, v20, v20, v5
    v_perm_b32 v50, v20, v20, v6
    v_perm_b32 v51, v20, v20, v7
    v_mfma_f32_16x16x32_bf16 v[44:47], v[120:123], v[52:55], v[44:47]
    v_perm_b32 v52, v21, v21, v4
    v_perm_b32 v53, v21, v21, v5
    v_perm_b32 v54, v21, v21, v6
    v_perm_b32 v55, v21, v21, v7
    s_waitcnt vmcnt(34)
    v_mfma_f32_16x16x32_bf16 v[32:35], v[124:127], v[48:51], v[32:35]
    v_perm_b32 v48, v22, v22, v4
    v_perm_b32 v49, v22, v22, v5
    v_perm_b32 v50, v22, v22, v6
    v_perm_b32 v51, v22, v22, v7
    v_mfma_f32_16x16x32_bf16 v[36:39], v[124:127], v[52:55], v[36:39]
    v_perm_b32 v52, v23, v23, v4
    v_perm_b32 v53, v23, v23, v5
    v_perm_b32 v54, v23, v23, v6
    v_perm_b32 v55, v23, v23, v7
    v_mfma_f32_16x16x32_bf16 v[40:43], v[124:127], v[48:51], v[40:43]
    s_nop 1
    v_mfma_f32_16x16x32_bf16 v[44:47], v[124:127], v[52:55], v[44:47]
    s_nop 7
    ds_write_b128 v30, v[32:35] offset:24832
    ds_write_b128 v30, v[36:39] offset:25856
    ds_write_b128 v30, v[40:43] offset:26880
    ds_write_b128 v30, v[44:47] offset:27904
    s_waitcnt lgkmcnt(0)
    s_barrier
    ds_read_b32 v32, v28 offset:24832
    ds_read_b32 v33, v28 offset:25472
    ds_read_b32 v34, v28 offset:28928
    ds_read_b32 v35, v28 offset:29568
    ds_read_b32 v36, v28 offset:33024
    ds_read_b32 v37, v28 offset:33664
    ds_read_b32 v38, v28 offset:37120
    ds_read_b32 v39, v28 offset:37760
    s_mul_i32 s47, s86, 0x3000
    s_lshl_b32 s50, s2, 8
    s_add_u32 s47, s47, s50
    s_add_u32 s47, s47, 4096
    v_lshlrev_b32 v12, 2, v1
    v_mov_b32 v42, s90
    v_mov_b32 v43, s91
    s_waitcnt lgkmcnt(0)
    v_add_f32 v32, v32, v36
    v_add_f32 v33, v33, v37
    v_add_f32 v34, v34, v38
    v_add_f32 v35, v35, v39
    v_add_f32 v32, v32, v33
    v_add_f32 v34, v34, v35
    v_add_f32 v32, v32, v34
    v_cvt_pk_bf16_f32 v32, 0, v32
    s_nop 1
    v_mov_b32_dpp v33, v32 quad_perm:[1,0,3,2] row_mask:0xf bank_mask:0xf
    v_perm_b32 v40, v33, v32, v29
    s_nop 1
    v_mov_b32_dpp v41, v40 quad_perm:[2,3,0,1] row_mask:0xf bank_mask:0xf
    s_mov_b32 exec_lo, 0x11111111
    s_mov_b32 exec_hi, 0x11111111
    buffer_store_dwordx4 v[40:43], v12, s[60:63], s47 offen sc1
    s_mov_b64 exec, -1
AUX_NP1:
    s_waitcnt vmcnt(32)
    v_lshlrev_b32 v40, 16, v60
    v_and_b32 v41, 0xffff0000, v60
    v_lshlrev_b32 v42, 16, v61
    v_and_b32 v43, 0xffff0000, v61
    v_lshlrev_b32 v44, 16, v62
    v_and_b32 v45, 0xffff0000, v62
    v_lshlrev_b32 v46, 16, v63
    v_and_b32 v47, 0xffff0000, v63
    v_lshlrev_b32 v30, 16, v19
    v_and_b32 v31, 0xffff0000, v19
    v_readfirstlane_b32 s47, v40
    s_nop 1
    v_subrev_f32 v40, s47, v40
    v_subrev_f32 v41, s47, v41
    v_subrev_f32 v42, s47, v42
    v_subrev_f32 v43, s47, v43
    v_subrev_f32 v44, s47, v44
    v_subrev_f32 v45, s47, v45
    v_subrev_f32 v46, s47, v46
    v_subrev_f32 v47, s47, v47
    v_add_f32 v48, v40, v41
    v_mul_f32 v49, v40, v40
    v_fmac_f32 v49, v41, v41
    v_add_f32 v48, v48, v42
    v_fmac_f32 v49, v42, v42
    v_add_f32 v48, v48, v43
    v_fmac_f32 v49, v43, v43
    v_add_f32 v48, v48, v44
    v_fmac_f32 v49, v44, v44
    v_add_f32 v48, v48, v45
    v_fmac_f32 v49, v45, v45
    v_add_f32 v48, v48, v46
    v_fmac_f32 v49, v46, v46
    v_add_f32 v48, v48, v47
    v_fmac_f32 v49, v47, v47
    s_nop 0
    v_add_f32_dpp v48, v48, v48 row_ror:8 row_mask:0xf bank_mask:0xf
    v_add_f32_dpp v49, v49, v49 row_ror:8 row_mask:0xf bank_mask:0xf
    s_nop 0
    v_add_f32_dpp v48, v48, v48 row_ror:4 row_mask:0xf bank_mask:0xf
    v_add_f32_dpp v49, v49, v49 row_ror:4 row_mask:0xf bank_mask:0xf
    s_nop 0
    v_add_f32_dpp v48, v48, v48 row_ror:2 row_mask:0xf bank_mask:0xf
    v_add_f32_dpp v49, v49, v49 row_ror:2 row_mask:0xf bank_mask:0xf
    s_nop 0
    v_add_f32_dpp v48, v48, v48 row_ror:1 row_mask:0xf bank_mask:0xf
    v_add_f32_dpp v49, v49, v49 row_ror:1 row_mask:0xf bank_mask:0xf
    v_mov_b32 v50, v48
    v_mov_b32 v51, v49
    s_nop 1
    v_permlane16_swap_b32 v48, v50
    v_permlane16_swap_b32 v49, v51
    s_nop 0
    v_add_f32 v48, v48, v50
    v_add_f32 v49, v49, v51
    v_mov_b32 v50, v48
    v_mov_b32 v51, v49
    s_nop 1
    v_permlane32_swap_b32 v48, v50
    v_permlane32_swap_b32 v49, v51
    s_nop 0
    v_add_f32 v48, v48, v50
    v_add_f32 v49, v49, v51
    v_mul_f32 v48, 0x3b000000, v48
    v_mul_f32 v49, 0x3b000000, v49
    v_fma_f32 v49, -v48, v48, v49
    v_max_f32 v49, 0, v49
    v_add_f32 v48, s47, v48
    v_cvt_pk_bf16_f32 v49, 0, v49
    v_cvt_pk_bf16_f32 v48, 0, v48
    v_add_f32 v49, 0x3727c5ac, v49
    v_cvt_pk_bf16_f32 v49, 0, v49
    v_sqrt_f32 v49, v49
    s_nop 0
    v_cvt_pk_bf16_f32 v49, 0, v49
    v_rcp_f32 v50, v49
    s_nop 0
    v_sub_f32 v30, v30, v48
    v_cvt_pk_bf16_f32 v30, 0, v30
    v_mul_f32 v32, v30, v50
    v_fma_f32 v30, -v32, v49, v30
    v_fma_f32 v30, v30, v50, v32
    v_cvt_pk_bf16_f32 v30, 0, v30
    v_sub_f32 v31, v31, v48
    v_cvt_pk_bf16_f32 v31, 0, v31
    v_mul_f32 v32, v31, v50
    v_fma_f32 v31, -v32, v49, v31
    v_fma_f32 v31, v31, v50, v32
    v_cvt_pk_bf16_f32 v31, 0, v31
    v_mov_b32 v59, 0
    v_and_b32 v19, 31, v1
    v_lshrrev_b32 v12, 5, v1
    v_lshl_add_u32 v19, v12, 7, v19
    v_lshlrev_b32 v19, 4, v19
    s_mul_i32 s81, s44, 0x3000
    s_lshl_b32 s82, s86, 9
    s_add_u32 s81, s81, s82
    s_add_u32 s81, s81, 4096
    v_and_b32 v60, 31, v1
    v_lshlrev_b32 v60, 2, v60
    v_lshl_add_u32 v60, v12, 8, v60
    v_add_u32 v60, s82, v60
    v_lshlrev_b32 v61, 7, v3
    v_add_u32 v61, s82, v61
    v_lshlrev_b32 v12, 2, v2
    v_lshl_add_u32 v12, v3, 8, v12
    s_lshl_b32 s47, s86, 10
    v_add_u32 v15, s47, v12
    s_mov_b32 s78, 100000
POLL_35:
    buffer_load_dwordx4 v[32:35], v19, s[60:63], s81 offen offset:0 sc1
    s_sub_u32 s78, s78, 1
    s_cbranch_scc1 ABORT
    s_waitcnt vmcnt(0)
    v_xor_b32 v36, s48, v34
    v_xor_b32 v37, s49, v35
    v_or_b32 v36, v36, v37
    v_cmp_ne_u32 vcc, 0, v36
    s_and_b64 exec, exec, vcc
    s_cbranch_execnz POLL_35
    s_mov_b64 exec, -1
    s_nop 4
    v_permlane32_swap_b32 v32, v33
    s_nop 0
    v_lshlrev_b32 v34, 16, v33
    v_and_b32 v35, 0xffff0000, v33
    v_lshlrev_b32 v36, 16, v32
    v_and_b32 v37, 0xffff0000, v32
    v_add_f32 v34, 1.0, v34
    v_add_f32 v35, 1.0, v35
    v_cvt_pk_bf16_f32 v34, 0, v34
    v_cvt_pk_bf16_f32 v35, 0, v35
    v_mul_f32 v30, v30, v34
    v_mul_f32 v31, v31, v35
    v_cvt_pk_bf16_f32 v30, 0, v30
    v_cvt_pk_bf16_f32 v31, 0, v31
    v_add_f32 v30, v30, v36
    v_add_f32 v31, v31, v37
    v_cvt_pk_bf16_f32 v30, v30, v30
    v_cvt_pk_bf16_f32 v31, v31, v31
    ds_write_b32 v60, v30 offset:18688
    ds_write_b32 v60, v31 offset:18816
    s_waitcnt lgkmcnt(0)
    ds_read_b128 v[96:99], v61 offset:18688
    ds_read_b128 v[100:103], v61 offset:18704
    ds_read_b128 v[104:107], v61 offset:18720
    ds_read_b128 v[108:111], v61 offset:18736
    ds_read_b128 v[112:115], v61 offset:18752
    ds_read_b128 v[116:119], v61 offset:18768
    ds_read_b128 v[120:123], v61 offset:18784
    ds_read_b128 v[124:127], v61 offset:18800
    s_waitcnt lgkmcnt(0)
    v_and_b32 v40, v96, v8
    v_and_b32 v41, v96, v9
    v_and_b32 v42, v96, v10
    v_and_b32 v43, v96, v11
    v_and_b32 v44, v97, v8
    v_and_b32 v45, v97, v9
    v_and_b32 v46, v97, v10
    v_and_b32 v47, v97, v11
    v_mfma_f32_16x16x32_bf16 v[52:55], v[128:131], v[40:43], 0
    v_and_b32 v48, v98, v8
    v_and_b32 v49, v98, v9
    v_and_b32 v50, v98, v10
    v_and_b32 v51, v98, v11
    v_mfma_f32_16x16x32_bf16 v[52:55], v[132:135], v[44:47], v[52:55]
    v_and_b32 v40, v99, v8
    v_and_b32 v41, v99, v9
    v_and_b32 v42, v99, v10
    v_and_b32 v43, v99, v11
    v_mfma_f32_16x16x32_bf16 v[52:55], v[136:139], v[48:51], v[52:55]
    v_and_b32 v44, v100, v8
    v_and_b32 v45, v100, v9
    v_and_b32 v46, v100, v10
    v_and_b32 v47, v100, v11
    v_mfma_f32_16x16x32_bf16 v[52:55], v[140:143], v[40:43], v[52:55]
    v_and_b32 v48, v101, v8
    v_and_b32 v49, v101, v9
    v_and_b32 v50, v101, v10
    v_and_b32 v51, v101, v11
    v_mfma_f32_16x16x32_bf16 v[52:55], v[144:147], v[44:47], v[52:55]
    v_and_b32 v40, v102, v8
    v_and_b32 v41, v102, v9
    v_and_b32 v42, v102, v10
    v_and_b32 v43, v102, v11
    v_mfma_f32_16x16x32_bf16 v[52:55], v[148:151], v[48:51], v[52:55]
    v_and_b32 v44, v103, v8
    v_and_b32 v45, v103, v9
    v_and_b32 v46, v103, v10
    v_and_b32 v47, v103, v11
    v_mfma_f32_16x16x32_bf16 v[52:55], v[152:155], v[40:43], v[52:55]
    v_and_b32 v48, v104, v8
    v_and_b32 v49, v104, v9
    v_and_b32 v50, v104, v10
    v_and_b32 v51, v104, v11
    v_mfma_f32_16x16x32_bf16 v[52:55], v[156:159], v[44:47], v[52:55]
    v_and_b32 v40, v105, v8
    v_and_b32 v41, v105, v9
    v_and_b32 v42, v105, v10
    v_and_b32 v43, v105, v11
    v_mfma_f32_16x16x32_bf16 v[52:55], v[160:163], v[48:51], v[52:55]
    v_and_b32 v44, v106, v8
    v_and_b32 v45, v106, v9
    v_and_b32 v46, v106, v10
    v_and_b32 v47, v106, v11
    v_mfma_f32_16x16x32_bf16 v[52:55], v[164:167], v[40:43], v[52:55]
    v_and_b32 v48, v107, v8
    v_and_b32 v49, v107, v9
    v_and_b32 v50, v107, v10
    v_and_b32 v51, v107, v11
    v_mfma_f32_16x16x32_bf16 v[52:55], v[168:171], v[44:47], v[52:55]
    v_and_b32 v40, v108, v8
    v_and_b32 v41, v108, v9
    v_and_b32 v42, v108, v10
    v_and_b32 v43, v108, v11
    v_mfma_f32_16x16x32_bf16 v[52:55], v[172:175], v[48:51], v[52:55]
    v_and_b32 v44, v109, v8
    v_and_b32 v45, v109, v9
    v_and_b32 v46, v109, v10
    v_and_b32 v47, v109, v11
    v_mfma_f32_16x16x32_bf16 v[52:55], v[176:179], v[40:43], v[52:55]
    v_and_b32 v48, v110, v8
    v_and_b32 v49, v110, v9
    v_and_b32 v50, v110, v10
    v_and_b32 v51, v110, v11
    v_mfma_f32_16x16x32_bf16 v[52:55], v[180:183], v[44:47], v[52:55]
    v_and_b32 v40, v111, v8
    v_and_b32 v41, v111, v9
    v_and_b32 v42, v111, v10
    v_and_b32 v43, v111, v11
    v_mfma_f32_16x16x32_bf16 v[52:55], v[184:187], v[48:51], v[52:55]
    v_and_b32 v44, v112, v8
    v_and_b32 v45, v112, v9
    v_and_b32 v46, v112, v10
    v_and_b32 v47, v112, v11
    v_mfma_f32_16x16x32_bf16 v[52:55], v[188:191], v[40:43], v[52:55]
    v_and_b32 v48, v113, v8
    v_and_b32 v49, v113, v9
    v_and_b32 v50, v113, v10
    v_and_b32 v51, v113, v11
    v_mfma_f32_16x16x32_bf16 v[52:55], v[192:195], v[44:47], v[52:55]
    v_and_b32 v40, v114, v8
    v_and_b32 v41, v114, v9
    v_and_b32 v42, v114, v10
    v_and_b32 v43, v114, v11
    v_mfma_f32_16x16x32_bf16 v[52:55], v[196:199], v[48:51], v[52:55]
    v_and_b32 v44, v115, v8
    v_and_b32 v45, v115, v9
    v_and_b32 v46, v115, v10
    v_and_b32 v47, v115, v11
    v_mfma_f32_16x16x32_bf16 v[52:55], v[200:203], v[40:43], v[52:55]
    v_and_b32 v48, v116, v8
    v_and_b32 v49, v116, v9
    v_and_b32 v50, v116, v10
    v_and_b32 v51, v116, v11
    v_mfma_f32_16x16x32_bf16 v[52:55], v[204:207], v[44:47], v[52:55]
    v_and_b32 v40, v117, v8
    v_and_b32 v41, v117, v9
    v_and_b32 v42, v117, v10
    v_and_b32 v43, v117, v11
    v_mfma_f32_16x16x32_bf16 v[52:55], v[208:211], v[48:51], v[52:55]
    v_and_b32 v44, v118, v8
    v_and_b32 v45, v118, v9
    v_and_b32 v46, v118, v10
    v_and_b32 v47, v118, v11
    v_mfma_f32_16x16x32_bf16 v[52:55], v[212:215], v[40:43], v[52:55]
    v_and_b32 v48, v119, v8
    v_and_b32 v49, v119, v9
    v_and_b32 v50, v119, v10
    v_and_b32 v51, v119, v11
    v_mfma_f32_16x16x32_bf16 v[52:55], v[216:219], v[44:47], v[52:55]
    v_and_b32 v40, v120, v8
    v_and_b32 v41, v120, v9
    v_and_b32 v42, v120, v10
    v_and_b32 v43, v120, v11
    v_mfma_f32_16x16x32_bf16 v[52:55], v[220:223], v[48:51], v[52:55]
    v_and_b32 v44, v121, v8
    v_and_b32 v45, v121, v9
    v_and_b32 v46, v121, v10
    v_and_b32 v47, v121, v11
    v_mfma_f32_16x16x32_bf16 v[52:55], v[224:227], v[40:43], v[52:55]
    v_and_b32 v48, v122, v8
    v_and_b32 v49, v122, v9
    v_and_b32 v50, v122, v10
    v_and_b32 v51, v122, v11
    v_mfma_f32_16x16x32_bf16 v[52:55], v[228:231], v[44:47], v[52:55]
    v_and_b32 v40, v123, v8
    v_and_b32 v41, v123, v9
    v_and_b32 v42, v123, v10
    v_and_b32 v43, v123, v11
    v_mfma_f32_16x16x32_bf16 v[52:55], v[232:235], v[48:51], v[52:55]
    v_and_b32 v44, v124, v8
    v_and_b32 v45, v124, v9
    v_and_b32 v46, v124, v10
    v_and_b32 v47, v124, v11
    v_mfma_f32_16x16x32_bf16 v[52:55], v[236:239], v[40:43], v[52:55]
    v_and_b32 v48, v125, v8
    v_and_b32 v49, v125, v9
    v_and_b32 v50, v125, v10
    v_and_b32 v51, v125, v11
    v_mfma_f32_16x16x32_bf16 v[52:55], v[240:243], v[44:47], v[52:55]
    v_and_b32 v40, v126, v8
    v_and_b32 v41, v126, v9
    v_and_b32 v42, v126, v10
    v_and_b32 v43, v126, v11
    v_mfma_f32_16x16x32_bf16 v[52:55], v[244:247], v[48:51], v[52:55]
    v_and_b32 v44, v127, v8
    v_and_b32 v45, v127, v9
    v_and_b32 v46, v127, v10
    v_and_b32 v47, v127, v11
    v_mfma_f32_16x16x32_bf16 v[52:55], v[248:251], v[40:43], v[52:55]
    s_nop 1
    v_mfma_f32_16x16x32_bf16 v[52:55], v[252:255], v[44:47], v[52:55]
    s_nop 7
    ds_write_b32 v15, v52 offset:0
    ds_write_b32 v15, v53 offset:64
    ds_write_b32 v15, v54 offset:128
    ds_write_b32 v15, v55 offset:192
    s_waitcnt lgkmcnt(0)
    s_barrier
    s_setprio 3
    s_mov_b32 s52, s24
    s_mov_b32 s53, s25
    s_mov_b32 s54, 4194304
    s_mov_b32 s55, 0x00020000
    v_lshlrev_b32 v18, 4, v2
    v_lshl_add_u32 v18, v3, 10, v18
    s_lshr_b32 s80, s45, 1
    s_lshl_b32 s80, s80, 17
    s_lshl_b32 s47, s86, 8
    s_add_u32 s80, s80, s47
    buffer_load_dwordx4 v[128:131], v18, s[52:55], s80 offen nt
    s_add_u32 s80, s80, 4096
    buffer_load_dwordx4 v[132:135], v18, s[52:55], s80 offen nt
    s_add_u32 s80, s80, 4096
    buffer_load_dwordx4 v[136:139], v18, s[52:55], s80 offen nt
    s_add_u32 s80, s80, 4096
    buffer_load_dwordx4 v[140:143], v18, s[52:55], s80 offen nt
    s_add_u32 s80, s80, 4096
    buffer_load_dwordx4 v[144:147], v18, s[52:55], s80 offen nt
    s_add_u32 s80, s80, 4096
    buffer_load_dwordx4 v[148:151], v18, s[52:55], s80 offen nt
    s_add_u32 s80, s80, 4096
    buffer_load_dwordx4 v[152:155], v18, s[52:55], s80 offen nt
    s_add_u32 s80, s80, 4096
    buffer_load_dwordx4 v[156:159], v18, s[52:55], s80 offen nt
    s_add_u32 s80, s80, 4096
    buffer_load_dwordx4 v[160:163], v18, s[52:55], s80 offen nt
    s_add_u32 s80, s80, 4096
    buffer_load_dwordx4 v[164:167], v18, s[52:55], s80 offen nt
    s_add_u32 s80, s80, 4096
    buffer_load_dwordx4 v[168:171], v18, s[52:55], s80 offen nt
    s_add_u32 s80, s80, 4096
    buffer_load_dwordx4 v[172:175], v18, s[52:55], s80 offen nt
    s_add_u32 s80, s80, 4096
    buffer_load_dwordx4 v[176:179], v18, s[52:55], s80 offen nt
    s_add_u32 s80, s80, 4096
    buffer_load_dwordx4 v[180:183], v18, s[52:55], s80 offen nt
    s_add_u32 s80, s80, 4096
    buffer_load_dwordx4 v[184:187], v18, s[52:55], s80 offen nt
    s_add_u32 s80, s80, 4096
    buffer_load_dwordx4 v[188:191], v18, s[52:55], s80 offen nt
    s_add_u32 s80, s80, 4096
    buffer_load_dwordx4 v[192:195], v18, s[52:55], s80 offen nt
    s_add_u32 s80, s80, 4096
    buffer_load_dwordx4 v[196:199], v18, s[52:55], s80 offen nt
    s_add_u32 s80, s80, 4096
    buffer_load_dwordx4 v[200:203], v18, s[52:55], s80 offen nt
    s_add_u32 s80, s80, 4096
    buffer_load_dwordx4 v[204:207], v18, s[52:55], s80 offen nt
    s_add_u32 s80, s80, 4096
    buffer_load_dwordx4 v[208:211], v18, s[52:55], s80 offen nt
    s_add_u32 s80, s80, 4096
    buffer_load_dwordx4 v[212:215], v18, s[52:55], s80 offen nt
    s_add_u32 s80, s80, 4096
    buffer_load_dwordx4 v[216:219], v18, s[52:55], s80 offen nt
    s_add_u32 s80, s80, 4096
    buffer_load_dwordx4 v[220:223], v18, s[52:55], s80 offen nt
    s_add_u32 s80, s80, 4096
    buffer_load_dwordx4 v[224:227], v18, s[52:55], s80 offen nt
    s_add_u32 s80, s80, 4096
    buffer_load_dwordx4 v[228:231], v18, s[52:55], s80 offen nt
    s_add_u32 s80, s80, 4096
    buffer_load_dwordx4 v[232:235], v18, s[52:55], s80 offen nt
    s_add_u32 s80, s80, 4096
    buffer_load_dwordx4 v[236:239], v18, s[52:55], s80 offen nt
    s_add_u32 s80, s80, 4096
    buffer_load_dwordx4 v[240:243], v18, s[52:55], s80 offen nt
    s_add_u32 s80, s80, 4096
    buffer_load_dwordx4 v[244:247], v18, s[52:55], s80 offen nt
    s_add_u32 s80, s80, 4096
    buffer_load_dwordx4 v[248:251], v18, s[52:55], s80 offen nt
    s_add_u32 s80, s80, 4096
    buffer_load_dwordx4 v[252:255], v18, s[52:55], s80 offen nt
    s_add_u32 s80, s80, 4096
    s_add_u32 s81, s81, 6144
    s_mov_b32 s78, 100000
POLL_37:
    buffer_load_dwordx4 v[32:35], v19, s[60:63], s81 offen offset:0 sc1
    s_sub_u32 s78, s78, 1
    s_cbranch_scc1 ABORT
    s_waitcnt vmcnt(0)
    v_xor_b32 v36, s48, v34
    v_xor_b32 v37, s49, v35
    v_or_b32 v36, v36, v37
    v_cmp_ne_u32 vcc, 0, v36
    s_and_b64 exec, exec, vcc
    s_cbranch_execnz POLL_37
    s_mov_b64 exec, -1
    s_nop 4
    v_permlane32_swap_b32 v32, v33
    s_nop 0
    v_lshlrev_b32 v34, 16, v33
    v_and_b32 v35, 0xffff0000, v33
    v_add_f32 v34, 1.0, v34
    v_add_f32 v35, 1.0, v35
    v_cvt_pk_bf16_f32 v34, v34, v35
    v_mov_b32 v35, v32
    v_and_b32 v12, 31, v1
    v_lshlrev_b32 v12, 4, v12
    v_lshrrev_b32 v13, 5, v1
    v_lshl_add_u32 v12, v13, 3, v12
    v_add_u32 v12, s82, v12
    ds_write_b64 v12, v[34:35] offset:16384
    s_cmp_lg_u32 s86, 0
    s_cbranch_scc1 AUX_B1
    s_lshr_b32 s47, s45, 2
    s_lshl_b32 s47, s47, 5
    s_and_b32 s50, s45, 3
    s_lshl_b32 s50, s50, 1
    s_add_u32 s47, s47, s50
    v_lshrrev_b32 v12, 5, v1
    v_bfe_u32 v13, v1, 4, 1
    v_lshl_add_u32 v12, v12, 1, v13
    v_lshlrev_b32 v12, 3, v12
    v_bfe_u32 v13, v1, 3, 1
    v_add3_u32 v12, v12, v13, s47
    v_lshlrev_b32 v59, 1, v12
    buffer_load_ushort v56, v59, s[72:75], s83 offen
    v_lshrrev_b32 v13, 2, v12
    v_lshlrev_b32 v13, 4, v13
    s_mul_i32 s81, s44, 0x3000
    s_add_u32 s81, s81, 8192
    s_add_u32 s82, s81, 6144
    s_mov_b32 s78, 100000
POLL_39:
    buffer_load_dwordx4 v[32:35], v13, s[60:63], s81 offen offset:0 sc1
    buffer_load_dwordx4 v[36:39], v13, s[60:63], s82 offen offset:0 sc1
    s_sub_u32 s78, s78, 1
    s_cbranch_scc1 ABORT
    s_waitcnt vmcnt(0)
    v_xor_b32 v40, s48, v34
    v_xor_b32 v41, s49, v35
    v_or_b32 v40, v40, v41
    v_xor_b32 v41, s48, v38
    v_or_b32 v40, v40, v41
    v_xor_b32 v41, s49, v39
    v_or_b32 v40, v40, v41
    v_cmp_ne_u32 vcc, 0, v40
    s_and_b64 exec, exec, vcc
    s_cbranch_execnz POLL_39
    s_mov_b64 exec, -1
    v_lshlrev_b32 v56, 16, v56
    v_and_b32 v13, 2, v12
    v_cmp_ne_u32 vcc, 0, v13
    s_nop 1
    v_cndmask_b32 v32, v32, v33, vcc
    v_cndmask_b32 v36, v36, v37, vcc
    v_and_b32 v13, 1, v12
    v_cmp_ne_u32 vcc, 0, v13
    v_lshlrev_b32 v33, 16, v32
    v_and_b32 v34, 0xffff0000, v32
    v_lshlrev_b32 v37, 16, v36
    v_and_b32 v38, 0xffff0000, v36
    v_cndmask_b32 v57, v33, v34, vcc
    v_cndmask_b32 v58, v37, v38, vcc
AUX_B1:
    v_lshrrev_b32 v62, 2, v1
    v_lshlrev_b32 v62, 6, v62
    v_and_b32 v12, 3, v1
    v_lshl_add_u32 v62, v12, 3, v62
    v_and_b32 v60, 1, v1
    v_lshlrev_b32 v60, 8, v60
    v_lshrrev_b32 v12, 1, v1
    v_lshl_add_u32 v60, v12, 2, v60
    s_lshl_b32 s82, s86, 9
    v_add_u32 v60, s82, v60
    v_mov_b32 v63, 0
    s_lshl_b32 s81, s87, 4
    s_add_u32 s81, s81, 65536
    s_mov_b64 exec, 0
    s_cmp_eq_u32 s86, 0
    s_cbranch_scc1 WP0_0
    s_cmp_eq_u32 s86, 1
    s_cbranch_scc1 WP1_0
    s_cmp_eq_u32 s86, 2
    s_cbranch_scc1 WP2_0
    s_cmp_eq_u32 s86, 3
    s_cbranch_scc1 WP3_0
WARM_RET:
    s_mov_b64 exec, -1
    s_waitcnt vmcnt(0) lgkmcnt(0)
    s_setprio 3
    s_barrier
WP0_0:
    s_cbranch_execz WP0_1
    ds_read_b128 v[32:35], v63 offset:18432
WP0_1:
    s_cbranch_execz WP0_2
    ds_read_b128 v[36:39], v63 offset:18448
    ds_read_b64 v[40:41], v62 offset:4096
    ds_read_b64 v[42:43], v62 offset:5120
    ds_read_b64 v[44:45], v62 offset:6144
    ds_read_b64 v[46:47], v62 offset:7168
    s_waitcnt lgkmcnt(4)
    v_max_f32 v24, v32, v34
    v_max3_f32 v24, v24, v36, v38
    v_sub_f32 v32, v32, v24
WP0_2:
    s_cbranch_execz WP0_3
    v_sub_f32 v34, v34, v24
    v_sub_f32 v36, v36, v24
    v_sub_f32 v38, v38, v24
    v_mul_f32 v32, 0x3fb8aa3b, v32
    v_mul_f32 v34, 0x3fb8aa3b, v34
    v_mul_f32 v36, 0x3fb8aa3b, v36
    v_mul_f32 v38, 0x3fb8aa3b, v38
    v_exp_f32 v32, v32
    v_exp_f32 v34, v34
    v_exp_f32 v36, v36
    v_exp_f32 v38, v38
WP0_3:
    s_cbranch_execz WP0_4
    s_waitcnt lgkmcnt(0)
    v_mul_f32 v48, v32, v40
    v_mul_f32 v49, v32, v41
    v_mul_f32 v25, v32, v33
    v_fmac_f32 v48, v34, v42
    v_fmac_f32 v49, v34, v43
    v_fmac_f32 v25, v34, v35
    v_fmac_f32 v48, v36, v44
    v_fmac_f32 v49, v36, v45
    v_fmac_f32 v25, v36, v37
    v_fmac_f32 v48, v38, v46
    v_fmac_f32 v49, v38, v47
    v_fmac_f32 v25, v38, v39
    v_cvt_pk_bf16_f32 v50, 0, v48
WP0_4:
    s_cbranch_execz WP0_5
    v_cvt_pk_bf16_f32 v51, 0, v49
    v_sub_f32 v50, v48, v50
    v_sub_f32 v51, v49, v51
    v_cvt_pk_bf16_f32 v48, v50, v48
    v_cvt_pk_bf16_f32 v49, v51, v49
    ds_write_b32 v60, v48 offset:18688
    ds_write_b32 v60, v49 offset:18816
    s_cmp_lg_u32 s86, 1
    s_cbranch_scc1 AUX_NOST
    s_mov_b64 exec, 1
WP0_5:
    s_cbranch_execz WP0_6
    buffer_store_dwordx4 v[24:27], v63, s[60:63], s81 offen sc1
    s_mov_b64 exec, -1
AUX_NOST:
    s_waitcnt lgkmcnt(0)
    ds_read_b128 v[96:99], v61 offset:18688
    ds_read_b128 v[100:103], v61 offset:18704
    ds_read_b128 v[104:107], v61 offset:18720
    ds_read_b128 v[108:111], v61 offset:18736
    ds_read_b128 v[112:115], v61 offset:18752
    ds_read_b128 v[116:119], v61 offset:18768
WP0_6:
    s_cbranch_execz WP0_7
    ds_read_b128 v[120:123], v61 offset:18784
    ds_read_b128 v[124:127], v61 offset:18800
    s_waitcnt lgkmcnt(0)
    v_perm_b32 v40, v96, v96, v4
    v_perm_b32 v41, v96, v96, v5
    v_perm_b32 v42, v96, v96, v6
    v_perm_b32 v43, v96, v96, v7
    v_perm_b32 v44, v97, v97, v4
WP0_7:
    s_cbranch_execz WP0_8
    v_perm_b32 v45, v97, v97, v5
    v_perm_b32 v46, v97, v97, v6
    v_perm_b32 v47, v97, v97, v7
    v_mfma_f32_16x16x32_bf16 v[52:55], v[128:131], v[40:43], 0
    v_perm_b32 v48, v98, v98, v4
    v_perm_b32 v49, v98, v98, v5
    v_perm_b32 v50, v98, v98, v6
WP0_8:
    s_cbranch_execz WP0_9
    v_perm_b32 v51, v98, v98, v7
    v_mfma_f32_16x16x32_bf16 v[52:55], v[132:135], v[44:47], v[52:55]
    v_perm_b32 v40, v99, v99, v4
    v_perm_b32 v41, v99, v99, v5
    v_perm_b32 v42, v99, v99, v6
    v_perm_b32 v43, v99, v99, v7
    v_mfma_f32_16x16x32_bf16 v[52:55], v[136:139], v[48:51], v[52:55]
    v_perm_b32 v44, v100, v100, v4
WP0_9:
    s_cbranch_execz WP0_10
    v_perm_b32 v45, v100, v100, v5
    v_perm_b32 v46, v100, v100, v6
    v_perm_b32 v47, v100, v100, v7
    v_mfma_f32_16x16x32_bf16 v[52:55], v[140:143], v[40:43], v[52:55]
    v_perm_b32 v48, v101, v101, v4
    v_perm_b32 v49, v101, v101, v5
    v_perm_b32 v50, v101, v101, v6
WP0_10:
    s_cbranch_execz WP0_11
    v_perm_b32 v51, v101, v101, v7
    v_mfma_f32_16x16x32_bf16 v[52:55], v[144:147], v[44:47], v[52:55]
    v_perm_b32 v40, v102, v102, v4
    v_perm_b32 v41, v102, v102, v5
    v_perm_b32 v42, v102, v102, v6
    v_perm_b32 v43, v102, v102, v7
    v_mfma_f32_16x16x32_bf16 v[52:55], v[148:151], v[48:51], v[52:55]
    v_perm_b32 v44, v103, v103, v4
WP0_11:
    s_cbranch_execz WP0_12
    v_perm_b32 v45, v103, v103, v5
    v_perm_b32 v46, v103, v103, v6
    v_perm_b32 v47, v103, v103, v7
    v_mfma_f32_16x16x32_bf16 v[52:55], v[152:155], v[40:43], v[52:55]
    v_perm_b32 v48, v104, v104, v4
    v_perm_b32 v49, v104, v104, v5
    v_perm_b32 v50, v104, v104, v6
WP0_12:
    s_cbranch_execz WP0_13
    v_perm_b32 v51, v104, v104, v7
    v_mfma_f32_16x16x32_bf16 v[52:55], v[156:159], v[44:47], v[52:55]
    v_perm_b32 v40, v105, v105, v4
    v_perm_b32 v41, v105, v105, v5
    v_perm_b32 v42, v105, v105, v6
    v_perm_b32 v43, v105, v105, v7
    v_mfma_f32_16x16x32_bf16 v[52:55], v[160:163], v[48:51], v[52:55]
    v_perm_b32 v44, v106, v106, v4
WP0_13:
    s_cbranch_execz WP0_14
    v_perm_b32 v45, v106, v106, v5
    v_perm_b32 v46, v106, v106, v6
    v_perm_b32 v47, v106, v106, v7
    v_mfma_f32_16x16x32_bf16 v[52:55], v[164:167], v[40:43], v[52:55]
    v_perm_b32 v48, v107, v107, v4
    v_perm_b32 v49, v107, v107, v5
    v_perm_b32 v50, v107, v107, v6
WP0_14:
    s_cbranch_execz WP0_15
    v_perm_b32 v51, v107, v107, v7
    v_mfma_f32_16x16x32_bf16 v[52:55], v[168:171], v[44:47], v[52:55]
    v_perm_b32 v40, v108, v108, v4
    v_perm_b32 v41, v108, v108, v5
    v_perm_b32 v42, v108, v108, v6
    v_perm_b32 v43, v108, v108, v7
    v_mfma_f32_16x16x32_bf16 v[52:55], v[172:175], v[48:51], v[52:55]
    v_perm_b32 v44, v109, v109, v4
WP0_15:
    s_cbranch_execz WP0_16
    v_perm_b32 v45, v109, v109, v5
    v_perm_b32 v46, v109, v109, v6
    v_perm_b32 v47, v109, v109, v7
    v_mfma_f32_16x16x32_bf16 v[52:55], v[176:179], v[40:43], v[52:55]
    v_perm_b32 v48, v110, v110, v4
    v_perm_b32 v49, v110, v110, v5
    v_perm_b32 v50, v110, v110, v6
WP0_16:
    s_cbranch_execz WP0_17
    v_perm_b32 v51, v110, v110, v7
    v_mfma_f32_16x16x32_bf16 v[52:55], v[180:183], v[44:47], v[52:55]
    v_perm_b32 v40, v111, v111, v4
    v_perm_b32 v41, v111, v111, v5
    v_perm_b32 v42, v111, v111, v6
    v_perm_b32 v43, v111, v111, v7
    v_mfma_f32_16x16x32_bf16 v[52:55], v[184:187], v[48:51], v[52:55]
    v_perm_b32 v44, v112, v112, v4
WP0_17:
    s_cbranch_execz WP0_18
    v_perm_b32 v45, v112, v112, v5
    v_perm_b32 v46, v112, v112, v6
    v_perm_b32 v47, v112, v112, v7
    v_mfma_f32_16x16x32_bf16 v[52:55], v[188:191], v[40:43], v[52:55]
    v_perm_b32 v48, v113, v113, v4
    v_perm_b32 v49, v113, v113, v5
    v_perm_b32 v50, v113, v113, v6
WP0_18:
    s_cbranch_execz WP0_19
    v_perm_b32 v51, v113, v113, v7
    v_mfma_f32_16x16x32_bf16 v[52:55], v[192:195], v[44:47], v[52:55]
    v_perm_b32 v40, v114, v114, v4
    v_perm_b32 v41, v114, v114, v5
    v_perm_b32 v42, v114, v114, v6
    v_perm_b32 v43, v114, v114, v7
    v_mfma_f32_16x16x32_bf16 v[52:55], v[196:199], v[48:51], v[52:55]
    v_perm_b32 v44, v115, v115, v4
WP0_19:
    s_cbranch_execz WP0_20
    v_perm_b32 v45, v115, v115, v5
    v_perm_b32 v46, v115, v115, v6
    v_perm_b32 v47, v115, v115, v7
    v_mfma_f32_16x16x32_bf16 v[52:55], v[200:203], v[40:43], v[52:55]
    v_perm_b32 v48, v116, v116, v4
    v_perm_b32 v49, v116, v116, v5
    v_perm_b32 v50, v116, v116, v6
WP0_20:
    s_cbranch_execz WP0_21
    v_perm_b32 v51, v116, v116, v7
    v_mfma_f32_16x16x32_bf16 v[52:55], v[204:207], v[44:47], v[52:55]
    v_perm_b32 v40, v117, v117, v4
    v_perm_b32 v41, v117, v117, v5
    v_perm_b32 v42, v117, v117, v6
    v_perm_b32 v43, v117, v117, v7
    v_mfma_f32_16x16x32_bf16 v[52:55], v[208:211], v[48:51], v[52:55]
    v_perm_b32 v44, v118, v118, v4
WP0_21:
    s_cbranch_execz WP0_22
    v_perm_b32 v45, v118, v118, v5
    v_perm_b32 v46, v118, v118, v6
    v_perm_b32 v47, v118, v118, v7
    v_mfma_f32_16x16x32_bf16 v[52:55], v[212:215], v[40:43], v[52:55]
    v_perm_b32 v48, v119, v119, v4
    v_perm_b32 v49, v119, v119, v5
    v_perm_b32 v50, v119, v119, v6
WP0_22:
    s_cbranch_execz WP0_23
    v_perm_b32 v51, v119, v119, v7
    v_mfma_f32_16x16x32_bf16 v[52:55], v[216:219], v[44:47], v[52:55]
    v_perm_b32 v40, v120, v120, v4
    v_perm_b32 v41, v120, v120, v5
    v_perm_b32 v42, v120, v120, v6
    v_perm_b32 v43, v120, v120, v7
    v_mfma_f32_16x16x32_bf16 v[52:55], v[220:223], v[48:51], v[52:55]
    v_perm_b32 v44, v121, v121, v4
WP0_23:
    s_cbranch_execz WP0_24
    v_perm_b32 v45, v121, v121, v5
    v_perm_b32 v46, v121, v121, v6
    v_perm_b32 v47, v121, v121, v7
    v_mfma_f32_16x16x32_bf16 v[52:55], v[224:227], v[40:43], v[52:55]
    v_perm_b32 v48, v122, v122, v4
    v_perm_b32 v49, v122, v122, v5
    v_perm_b32 v50, v122, v122, v6
WP0_24:
    s_cbranch_execz WP0_25
    v_perm_b32 v51, v122, v122, v7
    v_mfma_f32_16x16x32_bf16 v[52:55], v[228:231], v[44:47], v[52:55]
    v_perm_b32 v40, v123, v123, v4
    v_perm_b32 v41, v123, v123, v5
    v_perm_b32 v42, v123, v123, v6
    v_perm_b32 v43, v123, v123, v7
    v_mfma_f32_16x16x32_bf16 v[52:55], v[232:235], v[48:51], v[52:55]
    v_perm_b32 v44, v124, v124, v4
WP0_25:
    s_cbranch_execz WP0_26
    v_perm_b32 v45, v124, v124, v5
    v_perm_b32 v46, v124, v124, v6
    v_perm_b32 v47, v124, v124, v7
    v_mfma_f32_16x16x32_bf16 v[52:55], v[236:239], v[40:43], v[52:55]
    v_perm_b32 v48, v125, v125, v4
    v_perm_b32 v49, v125, v125, v5
    v_perm_b32 v50, v125, v125, v6
WP0_26:
    s_cbranch_execz WP0_27
    v_perm_b32 v51, v125, v125, v7
    v_mfma_f32_16x16x32_bf16 v[52:55], v[240:243], v[44:47], v[52:55]
    v_perm_b32 v40, v126, v126, v4
    v_perm_b32 v41, v126, v126, v5
    v_perm_b32 v42, v126, v126, v6
    v_perm_b32 v43, v126, v126, v7
    v_mfma_f32_16x16x32_bf16 v[52:55], v[244:247], v[48:51], v[52:55]
    v_perm_b32 v44, v127, v127, v4
WP0_27:
    s_cbranch_execz WP0_28
    v_perm_b32 v45, v127, v127, v5
    v_perm_b32 v46, v127, v127, v6
    v_perm_b32 v47, v127, v127, v7
    v_mfma_f32_16x16x32_bf16 v[52:55], v[248:251], v[40:43], v[52:55]
    s_nop 1
    v_mfma_f32_16x16x32_bf16 v[52:55], v[252:255], v[44:47], v[52:55]
    s_nop 7
    v_add_f32_dpp v24, v52, v52 row_ror:8 row_mask:0xf bank_mask:0x3
WP0_28:
    s_cbranch_execz WP0_29
    v_add_f32_dpp v25, v53, v53 row_ror:8 row_mask:0xf bank_mask:0x3
    v_add_f32_dpp v24, v54, v54 row_ror:8 row_mask:0xf bank_mask:0xc
    v_add_f32_dpp v25, v55, v55 row_ror:8 row_mask:0xf bank_mask:0xc
    s_mov_b32 s47, 1048576
    buffer_store_dwordx4 v[24:27], v16, s[60:63], s47 offen sc1
    s_cmp_lg_u32 s86, 0
    s_cbranch_scc1 ABORT
    v_lshlrev_b32 v12, 6, v1
    v_lshlrev_b32 v13, 4, v1
    s_lshl_b32 s81, s87, 12
WP0_29:
    s_cbranch_execz WP0_30
    s_add_u32 s82, s81, 1048576
    s_lshl_b32 s80, s44, 10
    s_add_u32 s80, s80, 65536
    s_mov_b32 s78, 100000
POLL_41:
    buffer_load_dwordx4 v[64:67], v12, s[60:63], s82 offen offset:0 sc1
    buffer_load_dwordx4 v[68:71], v12, s[60:63], s82 offen offset:16 sc1
    buffer_load_dwordx4 v[72:75], v12, s[60:63], s82 offen offset:32 sc1
    buffer_load_dwordx4 v[76:79], v12, s[60:63], s82 offen offset:48 sc1
WP0_30:
    s_cbranch_execz WP0_31
    buffer_load_dwordx4 v[80:83], v13, s[60:63], s80 offen offset:0 sc1
    s_sub_u32 s78, s78, 1
    s_cbranch_scc1 ABORT
    s_waitcnt vmcnt(0)
    v_xor_b32 v40, s48, v66
    v_xor_b32 v41, s49, v67
    v_or_b32 v40, v40, v41
    v_xor_b32 v41, s48, v70
    v_or_b32 v40, v40, v41
    v_xor_b32 v41, s49, v71
    v_or_b32 v40, v40, v41
    v_xor_b32 v41, s48, v74
    v_or_b32 v40, v40, v41
    v_xor_b32 v41, s49, v75
WP0_31:
    s_cbranch_execz WP0_32
    v_or_b32 v40, v40, v41
    v_xor_b32 v41, s48, v78
    v_or_b32 v40, v40, v41
    v_xor_b32 v41, s49, v79
    v_or_b32 v40, v40, v41
    v_xor_b32 v41, s48, v82
    v_or_b32 v40, v40, v41
    v_xor_b32 v41, s49, v83
    v_or_b32 v40, v40, v41
    v_cmp_ne_u32 vcc, 0, v40
    s_and_b64 exec, exec, vcc
    s_cbranch_execnz POLL_41
    s_mov_b64 exec, -1
    s_nop 4
    v_max_f32_dpp v40, v80, v80 quad_perm:[1,0,3,2] row_mask:0xf bank_mask:0xf
WP0_32:
    s_cbranch_execz WP0_33
    v_sub_f32 v40, v80, v40
    v_mul_f32 v40, 0x3fb8aa3b, v40
    v_exp_f32 v40, v40
    s_nop 0
    v_mul_f32 v41, v40, v81
    s_nop 1
    v_add_f32_dpp v41, v41, v41 quad_perm:[1,0,3,2] row_mask:0xf bank_mask:0xf
    v_rcp_f32 v41, v41
    s_nop 0
    v_mul_f32 v40, v40, v41
    v_mul_f32 v64, v64, v40
    v_mul_f32 v65, v65, v40
WP0_33:
    s_cbranch_execz WP0_34
    v_mul_f32 v68, v68, v40
    v_mul_f32 v69, v69, v40
    v_mul_f32 v72, v72, v40
    v_mul_f32 v73, v73, v40
    v_mul_f32 v76, v76, v40
    v_mul_f32 v77, v77, v40
    s_nop 0
    v_permlane32_swap_b32 v64, v68
    v_permlane32_swap_b32 v65, v69
    v_permlane32_swap_b32 v72, v76
    v_permlane32_swap_b32 v73, v77
    s_nop 0
    v_add_f32 v64, v64, v68
    v_add_f32 v65, v65, v69
    v_add_f32 v72, v72, v76
WP0_34:
    s_cbranch_execz WP0_35
    v_add_f32 v73, v73, v77
    s_nop 0
    v_permlane16_swap_b32 v64, v65
    v_permlane16_swap_b32 v72, v73
    s_nop 0
    v_add_f32 v64, v64, v65
    v_add_f32 v72, v72, v73
    s_nop 0
    v_add_f32_dpp v40, v64, v64 row_ror:8 row_mask:0xf bank_mask:0x3
    v_add_f32_dpp v40, v72, v72 row_ror:8 row_mask:0xf bank_mask:0xc
    s_nop 1
    v_add_f32_dpp v40, v40, v40 row_half_mirror row_mask:0xf bank_mask:0xf
WP0_35:
    s_cbranch_execz WP0_36
    s_nop 1
    v_add_f32_dpp v40, v40, v40 quad_perm:[1,0,3,2] row_mask:0xf bank_mask:0xf
    s_nop 1
    v_add_f32_dpp v40, v40, v40 quad_perm:[2,3,0,1] row_mask:0xf bank_mask:0xf
    v_cvt_pk_bf16_f32 v40, 0, v40
    v_mul_f32 v40, v57, v40
    v_cvt_pk_bf16_f32 v40, 0, v40
    v_add_f32 v40, v56, v40
    v_cvt_pk_bf16_f32 v56, 0, v40
    s_nop 1
WP0_36:
    s_cbranch_execz WP0_37
    v_mov_b32_dpp v41, v56 row_ror:8 row_mask:0xf bank_mask:0xf
    v_perm_b32 v24, v41, v56, v29
    v_mov_b32 v25, v24
    s_nop 1
    v_permlane16_swap_b32 v24, v25
    v_lshrrev_b32 v13, 5, v1
    v_lshlrev_b32 v13, 4, v13
    s_lshl_b32 s80, s87, 5
    s_add_u32 s80, s80, 73728
    s_mov_b32 exec_lo, 1
    s_mov_b32 exec_hi, 1
    buffer_store_dwordx4 v[24:27], v13, s[60:63], s80 offen sc1
WP0_37:
    s_cbranch_execz WP0_38
    s_mov_b64 exec, -1
    s_barrier
    s_cmp_lg_u32 s45, 0
    s_cbranch_scc1 AUX_NOEP
    s_lshl_b32 s80, s44, 8
    s_mov_b64 exec, 1
    buffer_store_dwordx2 v[26:27], v63, s[60:63], s80 offen sc1
    s_mov_b64 exec, -1
AUX_NOEP:
    v_mov_b32 v64, 0
    v_mov_b32 v65, 0
    v_mov_b32 v68, 0
    v_mov_b32 v69, 0
    v_mov_b32 v72, 0
WP0_38:
    s_cbranch_execz WP0_39
    v_mov_b32 v73, 0
    v_mov_b32 v76, 0
    v_mov_b32 v77, 0
    s_mov_b32 s64, s38
    s_mov_b32 s65, s39
    s_mov_b32 s66, 4096
    s_mov_b32 s67, 0x00020000
    s_add_u32 s82, s81, 2097152
    s_barrier
    s_mov_b32 s78, 100000
    s_mov_b32 exec_lo, -1
WP0_39:
    s_cbranch_execz WP0_40
    s_mov_b32 exec_hi, 0xffffff
POLL_43:
    buffer_load_dwordx4 v[64:67], v12, s[60:63], s82 offen offset:0 sc1
    buffer_load_dwordx4 v[68:71], v12, s[60:63], s82 offen offset:16 sc1
    buffer_load_dwordx4 v[72:75], v12, s[60:63], s82 offen offset:32 sc1
    buffer_load_dwordx4 v[76:79], v12, s[60:63], s82 offen offset:48 sc1
    s_sub_u32 s78, s78, 1
    s_cbranch_scc1 ABORT
    s_waitcnt vmcnt(0)
    v_xor_b32 v40, s48, v66
    v_xor_b32 v41, s49, v67
WP0_40:
    s_cbranch_execz WP0_41
    v_or_b32 v40, v40, v41
    v_xor_b32 v41, s48, v70
    v_or_b32 v40, v40, v41
    v_xor_b32 v41, s49, v71
    v_or_b32 v40, v40, v41
    v_xor_b32 v41, s48, v74
    v_or_b32 v40, v40, v41
    v_xor_b32 v41, s49, v75
    v_or_b32 v40, v40, v41
    v_xor_b32 v41, s48, v78
    v_or_b32 v40, v40, v41
    v_xor_b32 v41, s49, v79
    v_or_b32 v40, v40, v41
    v_cmp_ne_u32 vcc, 0, v40
    s_and_b64 exec, exec, vcc
    s_cbranch_execnz POLL_43
    s_mov_b64 exec, -1
WP0_41:
    s_cbranch_execz WP0_42
    s_nop 4
    v_permlane32_swap_b32 v64, v68
    v_permlane32_swap_b32 v65, v69
    v_permlane32_swap_b32 v72, v76
    v_permlane32_swap_b32 v73, v77
    s_nop 0
    v_add_f32 v64, v64, v68
    v_add_f32 v65, v65, v69
    v_add_f32 v72, v72, v76
    v_add_f32 v73, v73, v77
    s_nop 0
    v_permlane16_swap_b32 v64, v65
    v_permlane16_swap_b32 v72, v73
WP0_42:
    s_cbranch_execz WP0_43
    s_nop 0
    v_add_f32 v64, v64, v65
    v_add_f32 v72, v72, v73
    s_nop 0
    v_add_f32_dpp v40, v64, v64 row_ror:8 row_mask:0xf bank_mask:0x3
    v_add_f32_dpp v40, v72, v72 row_ror:8 row_mask:0xf bank_mask:0xc
    s_nop 1
    v_add_f32_dpp v40, v40, v40 row_half_mirror row_mask:0xf bank_mask:0xf
    s_nop 1
    v_add_f32_dpp v40, v40, v40 quad_perm:[1,0,3,2] row_mask:0xf bank_mask:0xf
    s_nop 1
WP0_43:
    s_cbranch_execz WP0_44
    v_add_f32_dpp v40, v40, v40 quad_perm:[2,3,0,1] row_mask:0xf bank_mask:0xf
    v_cvt_pk_bf16_f32 v40, 0, v40
    v_mul_f32 v40, v58, v40
    v_cvt_pk_bf16_f32 v40, 0, v40
    v_add_f32 v40, v56, v40
    v_cvt_pk_bf16_f32 v40, 0, v40
    s_nop 1
    v_mov_b32_dpp v41, v40 row_ror:8 row_mask:0xf bank_mask:0xf
    v_perm_b32 v24, v41, v40, v29
WP0_44:
    s_cbranch_execz WARM_RET
    s_mov_b32 exec_lo, 0x00010001
    s_mov_b32 exec_hi, 0x00010001
    buffer_store_dword v24, v59, s[64:67], s83 offen
ABORT:
    s_endpgm
AUX_W2:
    s_mov_b64 exec, 0
    s_cmp_eq_u32 s86, 0
    s_cbranch_scc1 WP4_0
    s_cmp_eq_u32 s86, 1
    s_cbranch_scc1 WP5_0
WARM_RET2:
    s_mov_b64 exec, -1
    s_branch AUX_NP1
.section .rodata,"a"
.p2align 6
.amdhsa_kernel adaLN_cond__mha_block_cached__glu_gated_glu__decode_kernel
  .amdhsa_next_free_vgpr 256
  .amdhsa_next_free_sgpr 102
  .amdhsa_accum_offset 256
  .amdhsa_group_segment_fixed_size 0
  .amdhsa_kernarg_size 112
  .amdhsa_user_sgpr_count 2
  .amdhsa_user_sgpr_kernarg_segment_ptr 1
  .amdhsa_system_sgpr_workgroup_id_x 1
.end_amdhsa_kernel
```
